```python
import torch

def _softmax(x, axis=-1):
    return torch.softmax(x, dim=axis)
def _gelu(x):
    return torch.nn.functional.gelu(x, approximate="tanh")
def _silu(x):
    return torch.nn.functional.silu(x)
def _sigmoid(x):
    return torch.sigmoid(x)
def _layernorm(x, axis=-1, eps=1e-5):
    m = x.mean(dim=axis, keepdim=True)
    v = x.var(dim=axis, keepdim=True, unbiased=False)
    return (x - m) / torch.sqrt(v + eps)
def _scatter_add(tgt, idx, src, axis=0):
    return tgt.clone().index_add_(axis, idx, src)
def _segment_sum(src, seg, n):
    out = torch.zeros((n,) + src.shape[1:], dtype=src.dtype)
    return out.index_add_(0, seg, src)
def _pad(x, pw):
    flat = tuple(v for pair in reversed(pw) for v in pair)
    return torch.nn.functional.pad(x, flat)

kernel_name = 'standalone__gqa_block_cached__decode'

def setup_inputs():

    _w = (lambda a: (lambda t: t.to(torch.bfloat16) if t.is_floating_point() else t)(torch.as_tensor(a)))
    B, Sq, D = 8, 1, 448
    Hq, Hkv, Sk, Dh = 16, 8, 4096, 256
    assert Hq % Hkv == 0, (Hq, Hkv)
    return {
        "x": _w((lambda *s: torch.randn(*s, dtype=torch.bfloat16) * 0.8)(B, Sq, D)),
        "k_cache": _w((lambda *s: torch.randn(*s, dtype=torch.bfloat16) * 0.8)(B, Hkv, Sk, Dh)),
        "v_cache": _w((lambda *s: torch.randn(*s, dtype=torch.bfloat16) * 0.05)(B, Hkv, Sk, Dh)),
        "wq": _w((lambda *s: torch.randn(*s, dtype=torch.bfloat16) * 0.8)(D, Hq * Dh) * (D ** -0.5)),
        "wo": _w((lambda *s: torch.randn(*s, dtype=torch.bfloat16) * 0.05)(Hq * Dh, D) * ((Hq * Dh) ** -0.5)),
    }

def reference(x, k_cache, v_cache, wq, wo):
    B, Sq, D = x.shape
    Hq, Dh = 16, 256
    Hkv = k_cache.shape[1]
    rep = Hq // Hkv
    q = (lambda x, *d: x.permute(*d))((x @ wq).reshape(B, Sq, Hq, Dh), 0, 2, 1, 3)
    k = (lambda x, n, axis: torch.repeat_interleave(x, n, dim=axis))(k_cache, rep, axis=1)
    v = (lambda x, n, axis: torch.repeat_interleave(x, n, dim=axis))(v_cache, rep, axis=1)
    scores = torch.einsum("bhqd,bhkd->bhqk", q, k) * (Dh ** -0.5)
    p = _softmax(scores, axis=-1)
    o = torch.einsum("bhqk,bhkd->bhqd", p, v)
    return (lambda x, *d: x.permute(*d))(o, 0, 2, 1, 3).reshape(B, Sq, Hq * Dh) @ wo
```

```asm
; @launch grid=(256,1,1) block=(512,1,1) lds=155712
.amdgcn_target "amdgcn-amd-amdhsa--gfx950"
.text
.globl standalone__gqa_block_cached__decode_kernel
.p2align 8
.type standalone__gqa_block_cached__decode_kernel,@function
standalone__gqa_block_cached__decode_kernel:
    s_cmp_ge_u32 s2, 0x100
    s_cbranch_scc1 L_end
    s_load_dwordx16 s[4:19], s[0:1], 0
    v_lshrrev_b32 v2, 6, v0
    v_and_b32 v1, 63, v0
    s_and_b32 s20, s2, 7
    s_lshr_b32 s21, s2, 3
    v_readfirstlane_b32 s3, v2
    s_lshr_b32 s22, s21, 2
    s_and_b32 s23, s21, 3
    v_and_b32 v2, 15, v1
    v_lshrrev_b32 v3, 4, v1
    s_cmp_lt_u32 s3, 4
    s_cbranch_scc1 L_help
L_stream:
    s_sub_u32 s3, s3, 4
    s_lshl_b32 s40, s22, 3
    s_add_u32 s40, s40, s20
    s_lshl_b32 s40, s40, 21
    s_lshl_b32 s41, s23, 19
    s_add_u32 s40, s40, s41
    s_lshl_b32 s41, s3, 12
    s_lshl_b32 s42, s3, 15
    v_lshrrev_b32 v234, 5, v1
    v_and_b32 v235, 31, v1
    v_add_u32 v236, 0, v234
    v_xor_b32 v236, v236, v235
    v_lshlrev_b32 v236, 4, v236
    v_lshl_add_u32 v4, v234, 9, v236
    v_add_u32 v236, 2, v234
    v_xor_b32 v236, v236, v235
    v_lshlrev_b32 v236, 4, v236
    v_lshl_add_u32 v5, v234, 9, v236
    v_add_u32 v236, 4, v234
    v_xor_b32 v236, v236, v235
    v_lshlrev_b32 v236, 4, v236
    v_lshl_add_u32 v6, v234, 9, v236
    v_add_u32 v236, 6, v234
    v_xor_b32 v236, v236, v235
    v_lshlrev_b32 v236, 4, v236
    v_lshl_add_u32 v7, v234, 9, v236
    v_add_u32 v236, 8, v234
    v_xor_b32 v236, v236, v235
    v_lshlrev_b32 v236, 4, v236
    v_lshl_add_u32 v8, v234, 9, v236
    v_add_u32 v236, 10, v234
    v_xor_b32 v236, v236, v235
    v_lshlrev_b32 v236, 4, v236
    v_lshl_add_u32 v9, v234, 9, v236
    v_add_u32 v236, 12, v234
    v_xor_b32 v236, v236, v235
    v_lshlrev_b32 v236, 4, v236
    v_lshl_add_u32 v10, v234, 9, v236
    v_add_u32 v236, 14, v234
    v_xor_b32 v236, v236, v235
    v_lshlrev_b32 v236, 4, v236
    v_lshl_add_u32 v11, v234, 9, v236
    s_waitcnt lgkmcnt(0)
    s_add_u32 s24, s6, s40
    s_addc_u32 s25, s7, 0
    s_mov_b32 s26, 0x80000
    s_mov_b32 s27, 0x20000
    s_add_u32 s28, s8, s40
    s_addc_u32 s29, s9, 0
    s_mov_b32 s30, 0x80000
    s_mov_b32 s31, 0x20000
    s_barrier
    s_add_u32 m0, s42, 0
    s_add_u32 s43, s41, 0
    buffer_load_dwordx4 v4, s[24:27], s43 offen offset:0 sc0 sc1 nt lds
    buffer_load_dwordx4 v5, s[24:27], s43 offen offset:1024 sc0 sc1 nt lds
    s_add_u32 m0, s42, 0
    s_add_u32 s43, s41, 0
    buffer_load_dwordx4 v6, s[24:27], s43 offen offset:2048 sc0 sc1 nt lds
    buffer_load_dwordx4 v7, s[24:27], s43 offen offset:3072 sc0 sc1 nt lds
    s_add_u32 m0, s42, 4096
    s_add_u32 s43, s41, 16384
    buffer_load_dwordx4 v8, s[24:27], s43 offen offset:0 sc0 sc1 nt lds
    buffer_load_dwordx4 v9, s[24:27], s43 offen offset:1024 sc0 sc1 nt lds
    v_add_u32 v236, 0, v234
    v_lshlrev_b32 v236, 1, v236
    v_xor_b32 v236, v236, v235
    v_lshlrev_b32 v236, 4, v236
    v_lshl_add_u32 v12, v234, 9, v236
    v_add_u32 v236, 2, v234
    v_lshlrev_b32 v236, 1, v236
    v_xor_b32 v236, v236, v235
    v_lshlrev_b32 v236, 4, v236
    v_lshl_add_u32 v13, v234, 9, v236
    v_add_u32 v236, 4, v234
    v_lshlrev_b32 v236, 1, v236
    v_xor_b32 v236, v236, v235
    v_lshlrev_b32 v236, 4, v236
    v_lshl_add_u32 v14, v234, 9, v236
    v_add_u32 v236, 6, v234
    v_lshlrev_b32 v236, 1, v236
    v_xor_b32 v236, v236, v235
    v_lshlrev_b32 v236, 4, v236
    v_lshl_add_u32 v15, v234, 9, v236
    v_lshl_add_u32 v237, v2, 9, s42
    v_add_u32 v236, 0, v3
    v_xor_b32 v236, v236, v2
    v_lshl_add_u32 v16, v236, 4, v237
    v_add_u32 v236, 4, v3
    v_xor_b32 v236, v236, v2
    v_lshl_add_u32 v17, v236, 4, v237
    v_add_u32 v236, 8, v3
    v_xor_b32 v236, v236, v2
    v_lshl_add_u32 v18, v236, 4, v237
    v_add_u32 v236, 12, v3
    v_xor_b32 v236, v236, v2
    v_lshl_add_u32 v19, v236, 4, v237
    v_lshrrev_b32 v236, 2, v2
    v_lshl_add_u32 v236, v3, 2, v236
    v_lshl_add_u32 v237, v236, 9, s42
    v_and_b32 v238, 1, v2
    v_lshl_add_u32 v237, v238, 3, v237
    v_and_b32 v236, 7, v236
    v_lshlrev_b32 v236, 1, v236
    v_bfe_u32 v238, v2, 1, 1
    v_add_u32 v239, 0, v238
    v_xor_b32 v239, v239, v236
    v_lshl_add_u32 v20, v239, 4, v237
    v_add_u32 v239, 2, v238
    v_xor_b32 v239, v239, v236
    v_lshl_add_u32 v21, v239, 4, v237
    v_add_u32 v239, 4, v238
    v_xor_b32 v239, v239, v236
    v_lshl_add_u32 v22, v239, 4, v237
    v_add_u32 v239, 6, v238
    v_xor_b32 v239, v239, v236
    v_lshl_add_u32 v23, v239, 4, v237
    v_add_u32 v239, 8, v238
    v_xor_b32 v239, v239, v236
    v_lshl_add_u32 v24, v239, 4, v237
    v_add_u32 v239, 10, v238
    v_xor_b32 v239, v239, v236
    v_lshl_add_u32 v25, v239, 4, v237
    v_add_u32 v239, 12, v238
    v_xor_b32 v239, v239, v236
    v_lshl_add_u32 v26, v239, 4, v237
    v_add_u32 v239, 14, v238
    v_xor_b32 v239, v239, v236
    v_lshl_add_u32 v27, v239, 4, v237
    v_mov_b32 v224, 0x3f803f80
    v_mov_b32 v225, 0x3f803f80
    v_mov_b32 v232, 0xff800000
    s_mov_b32 s44, 0x3db8aa3b
    v_and_b32 v236, 1, v2
    v_lshlrev_b32 v236, 9, v236
    v_lshl_add_u32 v236, v3, 4, v236
    v_add_u32 v240, 145408, v236
    s_lshl_b32 s45, s3, 11
    s_add_u32 s45, s45, 146432
    v_lshl_add_u32 v241, v2, 3, s45
    s_lshl_b32 s45, s3, 4
    s_add_u32 s45, s45, 154624
    v_lshl_add_u32 v242, v2, 3, s45
    s_waitcnt vmcnt(4)
    s_add_u32 m0, s42, 4096
    s_add_u32 s43, s41, 16384
    buffer_load_dwordx4 v10, s[24:27], s43 offen offset:2048 sc0 sc1 nt lds
    buffer_load_dwordx4 v11, s[24:27], s43 offen offset:3072 sc0 sc1 nt lds
    s_waitcnt vmcnt(4)
    s_add_u32 m0, s42, 8192
    s_add_u32 s43, s41, 32768
    buffer_load_dwordx4 v4, s[24:27], s43 offen offset:0 sc0 sc1 nt lds
    buffer_load_dwordx4 v5, s[24:27], s43 offen offset:1024 sc0 sc1 nt lds
    s_waitcnt vmcnt(4)
    s_add_u32 m0, s42, 8192
    s_add_u32 s43, s41, 32768
    buffer_load_dwordx4 v6, s[24:27], s43 offen offset:2048 sc0 sc1 nt lds
    buffer_load_dwordx4 v7, s[24:27], s43 offen offset:3072 sc0 sc1 nt lds
    s_waitcnt vmcnt(4)
    s_add_u32 m0, s42, 12288
    s_add_u32 s43, s41, 49152
    buffer_load_dwordx4 v8, s[24:27], s43 offen offset:0 sc0 sc1 nt lds
    buffer_load_dwordx4 v9, s[24:27], s43 offen offset:1024 sc0 sc1 nt lds
    s_waitcnt vmcnt(4)
    s_add_u32 m0, s42, 12288
    s_add_u32 s43, s41, 49152
    buffer_load_dwordx4 v10, s[24:27], s43 offen offset:2048 sc0 sc1 nt lds
    buffer_load_dwordx4 v11, s[24:27], s43 offen offset:3072 sc0 sc1 nt lds
    s_waitcnt vmcnt(4)
    s_add_u32 m0, s42, 16384
    s_add_u32 s43, s41, 65536
    buffer_load_dwordx4 v4, s[24:27], s43 offen offset:0 sc0 sc1 nt lds
    buffer_load_dwordx4 v5, s[24:27], s43 offen offset:1024 sc0 sc1 nt lds
    s_waitcnt vmcnt(4)
    s_add_u32 m0, s42, 16384
    s_add_u32 s43, s41, 65536
    buffer_load_dwordx4 v6, s[24:27], s43 offen offset:2048 sc0 sc1 nt lds
    buffer_load_dwordx4 v7, s[24:27], s43 offen offset:3072 sc0 sc1 nt lds
    s_waitcnt vmcnt(4)
    s_add_u32 m0, s42, 20480
    s_add_u32 s43, s41, 81920
    buffer_load_dwordx4 v8, s[24:27], s43 offen offset:0 sc0 sc1 nt lds
    buffer_load_dwordx4 v9, s[24:27], s43 offen offset:1024 sc0 sc1 nt lds
    s_waitcnt vmcnt(4)
    s_add_u32 m0, s42, 20480
    s_add_u32 s43, s41, 81920
    buffer_load_dwordx4 v10, s[24:27], s43 offen offset:2048 sc0 sc1 nt lds
    buffer_load_dwordx4 v11, s[24:27], s43 offen offset:3072 sc0 sc1 nt lds
    s_waitcnt vmcnt(4)
    s_add_u32 m0, s42, 24576
    s_add_u32 s43, s41, 98304
    buffer_load_dwordx4 v4, s[24:27], s43 offen offset:0 sc0 sc1 nt lds
    buffer_load_dwordx4 v5, s[24:27], s43 offen offset:1024 sc0 sc1 nt lds
    s_waitcnt vmcnt(4)
    s_add_u32 m0, s42, 24576
    s_add_u32 s43, s41, 98304
    buffer_load_dwordx4 v6, s[24:27], s43 offen offset:2048 sc0 sc1 nt lds
    buffer_load_dwordx4 v7, s[24:27], s43 offen offset:3072 sc0 sc1 nt lds
    s_waitcnt vmcnt(4)
    s_add_u32 m0, s42, 28672
    s_add_u32 s43, s41, 114688
    buffer_load_dwordx4 v8, s[24:27], s43 offen offset:0 sc0 sc1 nt lds
    buffer_load_dwordx4 v9, s[24:27], s43 offen offset:1024 sc0 sc1 nt lds
    s_waitcnt vmcnt(4)
    s_add_u32 m0, s42, 28672
    s_add_u32 s43, s41, 114688
    buffer_load_dwordx4 v10, s[24:27], s43 offen offset:2048 sc0 sc1 nt lds
    buffer_load_dwordx4 v11, s[24:27], s43 offen offset:3072 sc0 sc1 nt lds
    ds_read_b128 v[156:159], v16 offset:0
    ds_read_b128 v[160:163], v17 offset:0
    ds_read_b128 v[164:167], v18 offset:0
    ds_read_b128 v[168:171], v19 offset:0
    ds_read_b128 v[172:175], v16 offset:256
    ds_read_b128 v[176:179], v17 offset:256
    ds_read_b128 v[180:183], v18 offset:256
    ds_read_b128 v[184:187], v19 offset:256
    s_waitcnt lgkmcnt(0)
    s_waitcnt vmcnt(4)
    s_add_u32 m0, s42, 0
    s_add_u32 s43, s41, 131072
    buffer_load_dwordx4 v4, s[24:27], s43 offen offset:0 sc0 sc1 nt lds
    buffer_load_dwordx4 v5, s[24:27], s43 offen offset:1024 sc0 sc1 nt lds
    s_waitcnt vmcnt(4)
    s_add_u32 m0, s42, 0
    s_add_u32 s43, s41, 131072
    buffer_load_dwordx4 v6, s[24:27], s43 offen offset:2048 sc0 sc1 nt lds
    buffer_load_dwordx4 v7, s[24:27], s43 offen offset:3072 sc0 sc1 nt lds
    s_waitcnt vmcnt(4)
    s_add_u32 m0, s42, 4096
    s_add_u32 s43, s41, 147456
    buffer_load_dwordx4 v8, s[24:27], s43 offen offset:0 sc0 sc1 nt lds
    buffer_load_dwordx4 v9, s[24:27], s43 offen offset:1024 sc0 sc1 nt lds
    s_waitcnt vmcnt(4)
    s_add_u32 m0, s42, 4096
    s_add_u32 s43, s41, 147456
    buffer_load_dwordx4 v10, s[24:27], s43 offen offset:2048 sc0 sc1 nt lds
    buffer_load_dwordx4 v11, s[24:27], s43 offen offset:3072 sc0 sc1 nt lds
    ds_read_b128 v[188:191], v16 offset:8192
    ds_read_b128 v[192:195], v17 offset:8192
    ds_read_b128 v[196:199], v18 offset:8192
    ds_read_b128 v[200:203], v19 offset:8192
    ds_read_b128 v[204:207], v16 offset:8448
    ds_read_b128 v[208:211], v17 offset:8448
    ds_read_b128 v[212:215], v18 offset:8448
    ds_read_b128 v[216:219], v19 offset:8448
    s_waitcnt lgkmcnt(0)
    s_waitcnt vmcnt(4)
    s_add_u32 m0, s42, 8192
    s_add_u32 s43, s41, 163840
    buffer_load_dwordx4 v4, s[24:27], s43 offen offset:0 sc0 sc1 nt lds
    buffer_load_dwordx4 v5, s[24:27], s43 offen offset:1024 sc0 sc1 nt lds
    s_waitcnt vmcnt(4)
    s_add_u32 m0, s42, 8192
    s_add_u32 s43, s41, 163840
    buffer_load_dwordx4 v6, s[24:27], s43 offen offset:2048 sc0 sc1 nt lds
    buffer_load_dwordx4 v7, s[24:27], s43 offen offset:3072 sc0 sc1 nt lds
    s_waitcnt vmcnt(4)
    s_add_u32 m0, s42, 12288
    s_add_u32 s43, s41, 180224
    buffer_load_dwordx4 v8, s[24:27], s43 offen offset:0 sc0 sc1 nt lds
    buffer_load_dwordx4 v9, s[24:27], s43 offen offset:1024 sc0 sc1 nt lds
    s_waitcnt vmcnt(4)
    s_add_u32 m0, s42, 12288
    s_add_u32 s43, s41, 180224
    buffer_load_dwordx4 v10, s[24:27], s43 offen offset:2048 sc0 sc1 nt lds
    buffer_load_dwordx4 v11, s[24:27], s43 offen offset:3072 sc0 sc1 nt lds
    ds_read_b128 v[124:127], v16 offset:16384
    ds_read_b128 v[128:131], v17 offset:16384
    ds_read_b128 v[132:135], v18 offset:16384
    ds_read_b128 v[136:139], v19 offset:16384
    ds_read_b128 v[140:143], v16 offset:16640
    ds_read_b128 v[144:147], v17 offset:16640
    ds_read_b128 v[148:151], v18 offset:16640
    ds_read_b128 v[152:155], v19 offset:16640
    s_waitcnt lgkmcnt(0)
    s_waitcnt vmcnt(4)
    s_add_u32 m0, s42, 16384
    s_add_u32 s43, s41, 196608
    buffer_load_dwordx4 v4, s[24:27], s43 offen offset:0 sc0 sc1 nt lds
    buffer_load_dwordx4 v5, s[24:27], s43 offen offset:1024 sc0 sc1 nt lds
    s_waitcnt vmcnt(4)
    s_add_u32 m0, s42, 16384
    s_add_u32 s43, s41, 196608
    buffer_load_dwordx4 v6, s[24:27], s43 offen offset:2048 sc0 sc1 nt lds
    buffer_load_dwordx4 v7, s[24:27], s43 offen offset:3072 sc0 sc1 nt lds
    s_waitcnt vmcnt(4)
    s_add_u32 m0, s42, 20480
    s_add_u32 s43, s41, 212992
    buffer_load_dwordx4 v8, s[24:27], s43 offen offset:0 sc0 sc1 nt lds
    buffer_load_dwordx4 v9, s[24:27], s43 offen offset:1024 sc0 sc1 nt lds
    s_waitcnt vmcnt(4)
    s_add_u32 m0, s42, 20480
    s_add_u32 s43, s41, 212992
    buffer_load_dwordx4 v10, s[24:27], s43 offen offset:2048 sc0 sc1 nt lds
    buffer_load_dwordx4 v11, s[24:27], s43 offen offset:3072 sc0 sc1 nt lds
    s_barrier
    ds_read_b128 v[28:31], v240 offset:0
    ds_read_b128 v[32:35], v240 offset:64
    ds_read_b128 v[36:39], v240 offset:128
    ds_read_b128 v[40:43], v240 offset:192
    ds_read_b128 v[44:47], v240 offset:256
    ds_read_b128 v[48:51], v240 offset:320
    ds_read_b128 v[52:55], v240 offset:384
    ds_read_b128 v[56:59], v240 offset:448
    ds_read_b128 v[60:63], v16 offset:24576
    ds_read_b128 v[64:67], v17 offset:24576
    ds_read_b128 v[68:71], v18 offset:24576
    ds_read_b128 v[72:75], v19 offset:24576
    ds_read_b128 v[76:79], v16 offset:24832
    ds_read_b128 v[80:83], v17 offset:24832
    ds_read_b128 v[84:87], v18 offset:24832
    ds_read_b128 v[88:91], v19 offset:24832
    s_waitcnt lgkmcnt(0)
    s_waitcnt vmcnt(4)
    s_add_u32 m0, s42, 24576
    s_add_u32 s43, s41, 229376
    buffer_load_dwordx4 v4, s[24:27], s43 offen offset:0 sc0 sc1 nt lds
    buffer_load_dwordx4 v5, s[24:27], s43 offen offset:1024 sc0 sc1 nt lds
    s_waitcnt vmcnt(4)
    s_add_u32 m0, s42, 24576
    s_add_u32 s43, s41, 229376
    buffer_load_dwordx4 v6, s[24:27], s43 offen offset:2048 sc0 sc1 nt lds
    buffer_load_dwordx4 v7, s[24:27], s43 offen offset:3072 sc0 sc1 nt lds
    v_mfma_f32_16x16x32_bf16 v[92:95], v[156:159], v[28:31], 0
    v_mfma_f32_16x16x32_bf16 v[92:95], v[160:163], v[32:35], v[92:95]
    v_mfma_f32_16x16x32_bf16 v[92:95], v[164:167], v[36:39], v[92:95]
    v_mfma_f32_16x16x32_bf16 v[92:95], v[168:171], v[40:43], v[92:95]
    v_mfma_f32_16x16x32_bf16 v[92:95], v[172:175], v[44:47], v[92:95]
    v_mfma_f32_16x16x32_bf16 v[92:95], v[176:179], v[48:51], v[92:95]
    v_mfma_f32_16x16x32_bf16 v[92:95], v[180:183], v[52:55], v[92:95]
    v_mfma_f32_16x16x32_bf16 v[92:95], v[184:187], v[56:59], v[92:95]
    v_mfma_f32_16x16x32_bf16 v[96:99], v[188:191], v[28:31], 0
    v_mfma_f32_16x16x32_bf16 v[96:99], v[192:195], v[32:35], v[96:99]
    v_mfma_f32_16x16x32_bf16 v[96:99], v[196:199], v[36:39], v[96:99]
    v_mfma_f32_16x16x32_bf16 v[96:99], v[200:203], v[40:43], v[96:99]
    v_mfma_f32_16x16x32_bf16 v[96:99], v[204:207], v[44:47], v[96:99]
    v_mfma_f32_16x16x32_bf16 v[96:99], v[208:211], v[48:51], v[96:99]
    v_mfma_f32_16x16x32_bf16 v[96:99], v[212:215], v[52:55], v[96:99]
    v_mfma_f32_16x16x32_bf16 v[96:99], v[216:219], v[56:59], v[96:99]
    v_max3_f32 v232, v232, v92, v93
    v_max3_f32 v232, v232, v94, v95
    v_mfma_f32_16x16x32_bf16 v[100:103], v[124:127], v[28:31], 0
    v_mfma_f32_16x16x32_bf16 v[100:103], v[128:131], v[32:35], v[100:103]
    v_mfma_f32_16x16x32_bf16 v[100:103], v[132:135], v[36:39], v[100:103]
    v_mfma_f32_16x16x32_bf16 v[100:103], v[136:139], v[40:43], v[100:103]
    v_mfma_f32_16x16x32_bf16 v[100:103], v[140:143], v[44:47], v[100:103]
    v_mfma_f32_16x16x32_bf16 v[100:103], v[144:147], v[48:51], v[100:103]
    v_mfma_f32_16x16x32_bf16 v[100:103], v[148:151], v[52:55], v[100:103]
    v_mfma_f32_16x16x32_bf16 v[100:103], v[152:155], v[56:59], v[100:103]
    v_max3_f32 v232, v232, v96, v97
    v_max3_f32 v232, v232, v98, v99
    v_mfma_f32_16x16x32_bf16 v[104:107], v[60:63], v[28:31], 0
    v_mfma_f32_16x16x32_bf16 v[104:107], v[64:67], v[32:35], v[104:107]
    v_mfma_f32_16x16x32_bf16 v[104:107], v[68:71], v[36:39], v[104:107]
    v_mfma_f32_16x16x32_bf16 v[104:107], v[72:75], v[40:43], v[104:107]
    v_mfma_f32_16x16x32_bf16 v[104:107], v[76:79], v[44:47], v[104:107]
    v_mfma_f32_16x16x32_bf16 v[104:107], v[80:83], v[48:51], v[104:107]
    v_mfma_f32_16x16x32_bf16 v[104:107], v[84:87], v[52:55], v[104:107]
    v_mfma_f32_16x16x32_bf16 v[104:107], v[88:91], v[56:59], v[104:107]
    v_max3_f32 v232, v232, v100, v101
    v_max3_f32 v232, v232, v102, v103
    ds_read_b128 v[60:63], v16 offset:0
    ds_read_b128 v[64:67], v17 offset:0
    ds_read_b128 v[68:71], v18 offset:0
    ds_read_b128 v[72:75], v19 offset:0
    ds_read_b128 v[76:79], v16 offset:256
    ds_read_b128 v[80:83], v17 offset:256
    ds_read_b128 v[84:87], v18 offset:256
    ds_read_b128 v[88:91], v19 offset:256
    s_waitcnt lgkmcnt(0)
    s_waitcnt vmcnt(4)
    s_add_u32 m0, s42, 28672
    s_add_u32 s43, s41, 245760
    buffer_load_dwordx4 v8, s[24:27], s43 offen offset:0 sc0 sc1 nt lds
    buffer_load_dwordx4 v9, s[24:27], s43 offen offset:1024 sc0 sc1 nt lds
    s_waitcnt vmcnt(4)
    s_add_u32 m0, s42, 28672
    s_add_u32 s43, s41, 245760
    buffer_load_dwordx4 v10, s[24:27], s43 offen offset:2048 sc0 sc1 nt lds
    buffer_load_dwordx4 v11, s[24:27], s43 offen offset:3072 sc0 sc1 nt lds
    v_mfma_f32_16x16x32_bf16 v[108:111], v[60:63], v[28:31], 0
    v_mfma_f32_16x16x32_bf16 v[108:111], v[64:67], v[32:35], v[108:111]
    v_mfma_f32_16x16x32_bf16 v[108:111], v[68:71], v[36:39], v[108:111]
    v_mfma_f32_16x16x32_bf16 v[108:111], v[72:75], v[40:43], v[108:111]
    v_mfma_f32_16x16x32_bf16 v[108:111], v[76:79], v[44:47], v[108:111]
    v_mfma_f32_16x16x32_bf16 v[108:111], v[80:83], v[48:51], v[108:111]
    v_mfma_f32_16x16x32_bf16 v[108:111], v[84:87], v[52:55], v[108:111]
    v_mfma_f32_16x16x32_bf16 v[108:111], v[88:91], v[56:59], v[108:111]
    v_max3_f32 v232, v232, v104, v105
    v_max3_f32 v232, v232, v106, v107
    ds_read_b128 v[60:63], v16 offset:8192
    ds_read_b128 v[64:67], v17 offset:8192
    ds_read_b128 v[68:71], v18 offset:8192
    ds_read_b128 v[72:75], v19 offset:8192
    ds_read_b128 v[76:79], v16 offset:8448
    ds_read_b128 v[80:83], v17 offset:8448
    ds_read_b128 v[84:87], v18 offset:8448
    ds_read_b128 v[88:91], v19 offset:8448
    s_waitcnt lgkmcnt(0)
    s_waitcnt vmcnt(4)
    s_add_u32 m0, s42, 0
    s_add_u32 s43, s41, 262144
    buffer_load_dwordx4 v4, s[24:27], s43 offen offset:0 sc0 sc1 nt lds
    buffer_load_dwordx4 v5, s[24:27], s43 offen offset:1024 sc0 sc1 nt lds
    s_waitcnt vmcnt(4)
    s_add_u32 m0, s42, 0
    s_add_u32 s43, s41, 262144
    buffer_load_dwordx4 v6, s[24:27], s43 offen offset:2048 sc0 sc1 nt lds
    buffer_load_dwordx4 v7, s[24:27], s43 offen offset:3072 sc0 sc1 nt lds
    v_mfma_f32_16x16x32_bf16 v[112:115], v[60:63], v[28:31], 0
    v_mfma_f32_16x16x32_bf16 v[112:115], v[64:67], v[32:35], v[112:115]
    v_mfma_f32_16x16x32_bf16 v[112:115], v[68:71], v[36:39], v[112:115]
    v_mfma_f32_16x16x32_bf16 v[112:115], v[72:75], v[40:43], v[112:115]
    v_mfma_f32_16x16x32_bf16 v[112:115], v[76:79], v[44:47], v[112:115]
    v_mfma_f32_16x16x32_bf16 v[112:115], v[80:83], v[48:51], v[112:115]
    v_mfma_f32_16x16x32_bf16 v[112:115], v[84:87], v[52:55], v[112:115]
    v_mfma_f32_16x16x32_bf16 v[112:115], v[88:91], v[56:59], v[112:115]
    v_max3_f32 v232, v232, v108, v109
    v_max3_f32 v232, v232, v110, v111
    ds_read_b128 v[60:63], v16 offset:16384
    ds_read_b128 v[64:67], v17 offset:16384
    ds_read_b128 v[68:71], v18 offset:16384
    ds_read_b128 v[72:75], v19 offset:16384
    ds_read_b128 v[76:79], v16 offset:16640
    ds_read_b128 v[80:83], v17 offset:16640
    ds_read_b128 v[84:87], v18 offset:16640
    ds_read_b128 v[88:91], v19 offset:16640
    s_waitcnt lgkmcnt(0)
    s_waitcnt vmcnt(4)
    s_add_u32 m0, s42, 4096
    s_add_u32 s43, s41, 278528
    buffer_load_dwordx4 v8, s[24:27], s43 offen offset:0 sc0 sc1 nt lds
    buffer_load_dwordx4 v9, s[24:27], s43 offen offset:1024 sc0 sc1 nt lds
    s_waitcnt vmcnt(4)
    s_add_u32 m0, s42, 4096
    s_add_u32 s43, s41, 278528
    buffer_load_dwordx4 v10, s[24:27], s43 offen offset:2048 sc0 sc1 nt lds
    buffer_load_dwordx4 v11, s[24:27], s43 offen offset:3072 sc0 sc1 nt lds
    v_mfma_f32_16x16x32_bf16 v[116:119], v[60:63], v[28:31], 0
    v_mfma_f32_16x16x32_bf16 v[116:119], v[64:67], v[32:35], v[116:119]
    v_mfma_f32_16x16x32_bf16 v[116:119], v[68:71], v[36:39], v[116:119]
    v_mfma_f32_16x16x32_bf16 v[116:119], v[72:75], v[40:43], v[116:119]
    v_mfma_f32_16x16x32_bf16 v[116:119], v[76:79], v[44:47], v[116:119]
    v_mfma_f32_16x16x32_bf16 v[116:119], v[80:83], v[48:51], v[116:119]
    v_mfma_f32_16x16x32_bf16 v[116:119], v[84:87], v[52:55], v[116:119]
    v_mfma_f32_16x16x32_bf16 v[116:119], v[88:91], v[56:59], v[116:119]
    v_max3_f32 v232, v232, v112, v113
    v_max3_f32 v232, v232, v114, v115
    ds_read_b128 v[60:63], v16 offset:24576
    ds_read_b128 v[64:67], v17 offset:24576
    ds_read_b128 v[68:71], v18 offset:24576
    ds_read_b128 v[72:75], v19 offset:24576
    ds_read_b128 v[76:79], v16 offset:24832
    ds_read_b128 v[80:83], v17 offset:24832
    ds_read_b128 v[84:87], v18 offset:24832
    ds_read_b128 v[88:91], v19 offset:24832
    s_waitcnt lgkmcnt(0)
    s_waitcnt vmcnt(4)
    s_add_u32 m0, s42, 8192
    s_add_u32 s43, s41, 294912
    buffer_load_dwordx4 v4, s[24:27], s43 offen offset:0 sc0 sc1 nt lds
    buffer_load_dwordx4 v5, s[24:27], s43 offen offset:1024 sc0 sc1 nt lds
    s_waitcnt vmcnt(4)
    s_add_u32 m0, s42, 8192
    s_add_u32 s43, s41, 294912
    buffer_load_dwordx4 v6, s[24:27], s43 offen offset:2048 sc0 sc1 nt lds
    buffer_load_dwordx4 v7, s[24:27], s43 offen offset:3072 sc0 sc1 nt lds
    v_mfma_f32_16x16x32_bf16 v[120:123], v[60:63], v[28:31], 0
    v_mfma_f32_16x16x32_bf16 v[120:123], v[64:67], v[32:35], v[120:123]
    v_mfma_f32_16x16x32_bf16 v[120:123], v[68:71], v[36:39], v[120:123]
    v_mfma_f32_16x16x32_bf16 v[120:123], v[72:75], v[40:43], v[120:123]
    v_mfma_f32_16x16x32_bf16 v[120:123], v[76:79], v[44:47], v[120:123]
    v_mfma_f32_16x16x32_bf16 v[120:123], v[80:83], v[48:51], v[120:123]
    v_mfma_f32_16x16x32_bf16 v[120:123], v[84:87], v[52:55], v[120:123]
    v_mfma_f32_16x16x32_bf16 v[120:123], v[88:91], v[56:59], v[120:123]
    v_max3_f32 v232, v232, v116, v117
    v_max3_f32 v232, v232, v118, v119
    s_waitcnt vmcnt(4)
    s_add_u32 m0, s42, 12288
    s_add_u32 s43, s41, 311296
    buffer_load_dwordx4 v8, s[24:27], s43 offen offset:0 sc0 sc1 nt lds
    buffer_load_dwordx4 v9, s[24:27], s43 offen offset:1024 sc0 sc1 nt lds
    ds_read_b128 v[60:63], v16 offset:0
    ds_read_b128 v[64:67], v17 offset:0
    ds_read_b128 v[68:71], v18 offset:0
    ds_read_b128 v[72:75], v19 offset:0
    ds_read_b128 v[76:79], v16 offset:256
    ds_read_b128 v[80:83], v17 offset:256
    ds_read_b128 v[84:87], v18 offset:256
    ds_read_b128 v[88:91], v19 offset:256
    s_waitcnt lgkmcnt(0)
    s_waitcnt vmcnt(4)
    s_add_u32 m0, s42, 12288
    s_add_u32 s43, s41, 311296
    buffer_load_dwordx4 v10, s[24:27], s43 offen offset:2048 sc0 sc1 nt lds
    buffer_load_dwordx4 v11, s[24:27], s43 offen offset:3072 sc0 sc1 nt lds
    v_mfma_f32_16x16x32_bf16 v[124:127], v[60:63], v[28:31], 0
    v_mfma_f32_16x16x32_bf16 v[124:127], v[64:67], v[32:35], v[124:127]
    v_mfma_f32_16x16x32_bf16 v[124:127], v[68:71], v[36:39], v[124:127]
    v_mfma_f32_16x16x32_bf16 v[124:127], v[72:75], v[40:43], v[124:127]
    v_mfma_f32_16x16x32_bf16 v[124:127], v[76:79], v[44:47], v[124:127]
    v_mfma_f32_16x16x32_bf16 v[124:127], v[80:83], v[48:51], v[124:127]
    v_mfma_f32_16x16x32_bf16 v[124:127], v[84:87], v[52:55], v[124:127]
    v_mfma_f32_16x16x32_bf16 v[124:127], v[88:91], v[56:59], v[124:127]
    v_max3_f32 v232, v232, v120, v121
    v_max3_f32 v232, v232, v122, v123
    s_waitcnt vmcnt(4)
    s_add_u32 m0, s42, 16384
    s_add_u32 s43, s41, 327680
    buffer_load_dwordx4 v4, s[24:27], s43 offen offset:0 sc0 sc1 nt lds
    buffer_load_dwordx4 v5, s[24:27], s43 offen offset:1024 sc0 sc1 nt lds
    s_waitcnt vmcnt(4)
    s_add_u32 m0, s42, 16384
    s_add_u32 s43, s41, 327680
    buffer_load_dwordx4 v6, s[24:27], s43 offen offset:2048 sc0 sc1 nt lds
    buffer_load_dwordx4 v7, s[24:27], s43 offen offset:3072 sc0 sc1 nt lds
    s_waitcnt vmcnt(4)
    s_add_u32 m0, s42, 20480
    s_add_u32 s43, s41, 344064
    buffer_load_dwordx4 v8, s[24:27], s43 offen offset:0 sc0 sc1 nt lds
    buffer_load_dwordx4 v9, s[24:27], s43 offen offset:1024 sc0 sc1 nt lds
    ds_read_b128 v[60:63], v16 offset:8192
    ds_read_b128 v[64:67], v17 offset:8192
    ds_read_b128 v[68:71], v18 offset:8192
    ds_read_b128 v[72:75], v19 offset:8192
    ds_read_b128 v[76:79], v16 offset:8448
    ds_read_b128 v[80:83], v17 offset:8448
    ds_read_b128 v[84:87], v18 offset:8448
    ds_read_b128 v[88:91], v19 offset:8448
    s_waitcnt lgkmcnt(0)
    s_waitcnt vmcnt(4)
    s_add_u32 m0, s42, 20480
    s_add_u32 s43, s41, 344064
    buffer_load_dwordx4 v10, s[24:27], s43 offen offset:2048 sc0 sc1 nt lds
    buffer_load_dwordx4 v11, s[24:27], s43 offen offset:3072 sc0 sc1 nt lds
    v_mfma_f32_16x16x32_bf16 v[128:131], v[60:63], v[28:31], 0
    v_mfma_f32_16x16x32_bf16 v[128:131], v[64:67], v[32:35], v[128:131]
    v_mfma_f32_16x16x32_bf16 v[128:131], v[68:71], v[36:39], v[128:131]
    v_mfma_f32_16x16x32_bf16 v[128:131], v[72:75], v[40:43], v[128:131]
    v_mfma_f32_16x16x32_bf16 v[128:131], v[76:79], v[44:47], v[128:131]
    v_mfma_f32_16x16x32_bf16 v[128:131], v[80:83], v[48:51], v[128:131]
    v_mfma_f32_16x16x32_bf16 v[128:131], v[84:87], v[52:55], v[128:131]
    v_mfma_f32_16x16x32_bf16 v[128:131], v[88:91], v[56:59], v[128:131]
    v_max3_f32 v232, v232, v124, v125
    v_max3_f32 v232, v232, v126, v127
    s_waitcnt vmcnt(4)
    s_add_u32 m0, s42, 24576
    s_add_u32 s43, s41, 360448
    buffer_load_dwordx4 v4, s[24:27], s43 offen offset:0 sc0 sc1 nt lds
    buffer_load_dwordx4 v5, s[24:27], s43 offen offset:1024 sc0 sc1 nt lds
    s_waitcnt vmcnt(4)
    s_add_u32 m0, s42, 24576
    s_add_u32 s43, s41, 360448
    buffer_load_dwordx4 v6, s[24:27], s43 offen offset:2048 sc0 sc1 nt lds
    buffer_load_dwordx4 v7, s[24:27], s43 offen offset:3072 sc0 sc1 nt lds
    s_waitcnt vmcnt(4)
    s_add_u32 m0, s42, 28672
    s_add_u32 s43, s41, 376832
    buffer_load_dwordx4 v8, s[24:27], s43 offen offset:0 sc0 sc1 nt lds
    buffer_load_dwordx4 v9, s[24:27], s43 offen offset:1024 sc0 sc1 nt lds
    ds_read_b128 v[60:63], v16 offset:16384
    ds_read_b128 v[64:67], v17 offset:16384
    ds_read_b128 v[68:71], v18 offset:16384
    ds_read_b128 v[72:75], v19 offset:16384
    ds_read_b128 v[76:79], v16 offset:16640
    ds_read_b128 v[80:83], v17 offset:16640
    ds_read_b128 v[84:87], v18 offset:16640
    ds_read_b128 v[88:91], v19 offset:16640
    s_waitcnt lgkmcnt(0)
    s_waitcnt vmcnt(4)
    s_add_u32 m0, s42, 28672
    s_add_u32 s43, s41, 376832
    buffer_load_dwordx4 v10, s[24:27], s43 offen offset:2048 sc0 sc1 nt lds
    buffer_load_dwordx4 v11, s[24:27], s43 offen offset:3072 sc0 sc1 nt lds
    v_mfma_f32_16x16x32_bf16 v[132:135], v[60:63], v[28:31], 0
    v_mfma_f32_16x16x32_bf16 v[132:135], v[64:67], v[32:35], v[132:135]
    v_mfma_f32_16x16x32_bf16 v[132:135], v[68:71], v[36:39], v[132:135]
    v_mfma_f32_16x16x32_bf16 v[132:135], v[72:75], v[40:43], v[132:135]
    v_mfma_f32_16x16x32_bf16 v[132:135], v[76:79], v[44:47], v[132:135]
    v_mfma_f32_16x16x32_bf16 v[132:135], v[80:83], v[48:51], v[132:135]
    v_mfma_f32_16x16x32_bf16 v[132:135], v[84:87], v[52:55], v[132:135]
    v_mfma_f32_16x16x32_bf16 v[132:135], v[88:91], v[56:59], v[132:135]
    v_max3_f32 v232, v232, v128, v129
    v_max3_f32 v232, v232, v130, v131
    s_waitcnt vmcnt(4)
    s_add_u32 m0, s42, 0
    s_add_u32 s43, s41, 393216
    buffer_load_dwordx4 v4, s[24:27], s43 offen offset:0 sc0 sc1 nt lds
    buffer_load_dwordx4 v5, s[24:27], s43 offen offset:1024 sc0 sc1 nt lds
    s_waitcnt vmcnt(4)
    s_add_u32 m0, s42, 0
    s_add_u32 s43, s41, 393216
    buffer_load_dwordx4 v6, s[24:27], s43 offen offset:2048 sc0 sc1 nt lds
    buffer_load_dwordx4 v7, s[24:27], s43 offen offset:3072 sc0 sc1 nt lds
    s_waitcnt vmcnt(4)
    s_add_u32 m0, s42, 4096
    s_add_u32 s43, s41, 409600
    buffer_load_dwordx4 v8, s[24:27], s43 offen offset:0 sc0 sc1 nt lds
    buffer_load_dwordx4 v9, s[24:27], s43 offen offset:1024 sc0 sc1 nt lds
    ds_read_b128 v[60:63], v16 offset:24576
    ds_read_b128 v[64:67], v17 offset:24576
    ds_read_b128 v[68:71], v18 offset:24576
    ds_read_b128 v[72:75], v19 offset:24576
    ds_read_b128 v[76:79], v16 offset:24832
    ds_read_b128 v[80:83], v17 offset:24832
    ds_read_b128 v[84:87], v18 offset:24832
    ds_read_b128 v[88:91], v19 offset:24832
    s_waitcnt lgkmcnt(0)
    s_waitcnt vmcnt(4)
    s_add_u32 m0, s42, 4096
    s_add_u32 s43, s41, 409600
    buffer_load_dwordx4 v10, s[24:27], s43 offen offset:2048 sc0 sc1 nt lds
    buffer_load_dwordx4 v11, s[24:27], s43 offen offset:3072 sc0 sc1 nt lds
    v_mfma_f32_16x16x32_bf16 v[136:139], v[60:63], v[28:31], 0
    v_mfma_f32_16x16x32_bf16 v[136:139], v[64:67], v[32:35], v[136:139]
    v_mfma_f32_16x16x32_bf16 v[136:139], v[68:71], v[36:39], v[136:139]
    v_mfma_f32_16x16x32_bf16 v[136:139], v[72:75], v[40:43], v[136:139]
    v_mfma_f32_16x16x32_bf16 v[136:139], v[76:79], v[44:47], v[136:139]
    v_mfma_f32_16x16x32_bf16 v[136:139], v[80:83], v[48:51], v[136:139]
    v_mfma_f32_16x16x32_bf16 v[136:139], v[84:87], v[52:55], v[136:139]
    v_mfma_f32_16x16x32_bf16 v[136:139], v[88:91], v[56:59], v[136:139]
    v_max3_f32 v232, v232, v132, v133
    v_max3_f32 v232, v232, v134, v135
    s_waitcnt vmcnt(4)
    s_add_u32 m0, s42, 8192
    s_add_u32 s43, s41, 425984
    buffer_load_dwordx4 v4, s[24:27], s43 offen offset:0 sc0 sc1 nt lds
    buffer_load_dwordx4 v5, s[24:27], s43 offen offset:1024 sc0 sc1 nt lds
    s_waitcnt vmcnt(4)
    s_add_u32 m0, s42, 8192
    s_add_u32 s43, s41, 425984
    buffer_load_dwordx4 v6, s[24:27], s43 offen offset:2048 sc0 sc1 nt lds
    buffer_load_dwordx4 v7, s[24:27], s43 offen offset:3072 sc0 sc1 nt lds
    s_waitcnt vmcnt(4)
    s_add_u32 m0, s42, 12288
    s_add_u32 s43, s41, 442368
    buffer_load_dwordx4 v8, s[24:27], s43 offen offset:0 sc0 sc1 nt lds
    buffer_load_dwordx4 v9, s[24:27], s43 offen offset:1024 sc0 sc1 nt lds
    ds_read_b128 v[60:63], v16 offset:0
    ds_read_b128 v[64:67], v17 offset:0
    ds_read_b128 v[68:71], v18 offset:0
    ds_read_b128 v[72:75], v19 offset:0
    ds_read_b128 v[76:79], v16 offset:256
    ds_read_b128 v[80:83], v17 offset:256
    ds_read_b128 v[84:87], v18 offset:256
    ds_read_b128 v[88:91], v19 offset:256
    s_waitcnt lgkmcnt(0)
    s_waitcnt vmcnt(4)
    s_add_u32 m0, s42, 12288
    s_add_u32 s43, s41, 442368
    buffer_load_dwordx4 v10, s[24:27], s43 offen offset:2048 sc0 sc1 nt lds
    buffer_load_dwordx4 v11, s[24:27], s43 offen offset:3072 sc0 sc1 nt lds
    v_mfma_f32_16x16x32_bf16 v[140:143], v[60:63], v[28:31], 0
    v_mfma_f32_16x16x32_bf16 v[140:143], v[64:67], v[32:35], v[140:143]
    v_mfma_f32_16x16x32_bf16 v[140:143], v[68:71], v[36:39], v[140:143]
    v_mfma_f32_16x16x32_bf16 v[140:143], v[72:75], v[40:43], v[140:143]
    v_mfma_f32_16x16x32_bf16 v[140:143], v[76:79], v[44:47], v[140:143]
    v_mfma_f32_16x16x32_bf16 v[140:143], v[80:83], v[48:51], v[140:143]
    v_mfma_f32_16x16x32_bf16 v[140:143], v[84:87], v[52:55], v[140:143]
    v_mfma_f32_16x16x32_bf16 v[140:143], v[88:91], v[56:59], v[140:143]
    v_max3_f32 v232, v232, v136, v137
    v_max3_f32 v232, v232, v138, v139
    s_waitcnt vmcnt(4)
    s_add_u32 m0, s42, 16384
    s_add_u32 s43, s41, 458752
    buffer_load_dwordx4 v4, s[24:27], s43 offen offset:0 sc0 sc1 nt lds
    buffer_load_dwordx4 v5, s[24:27], s43 offen offset:1024 sc0 sc1 nt lds
    s_waitcnt vmcnt(4)
    s_add_u32 m0, s42, 16384
    s_add_u32 s43, s41, 458752
    buffer_load_dwordx4 v6, s[24:27], s43 offen offset:2048 sc0 sc1 nt lds
    buffer_load_dwordx4 v7, s[24:27], s43 offen offset:3072 sc0 sc1 nt lds
    s_waitcnt vmcnt(4)
    s_add_u32 m0, s42, 20480
    s_add_u32 s43, s41, 475136
    buffer_load_dwordx4 v8, s[24:27], s43 offen offset:0 sc0 sc1 nt lds
    buffer_load_dwordx4 v9, s[24:27], s43 offen offset:1024 sc0 sc1 nt lds
    ds_read_b128 v[60:63], v16 offset:8192
    ds_read_b128 v[64:67], v17 offset:8192
    ds_read_b128 v[68:71], v18 offset:8192
    ds_read_b128 v[72:75], v19 offset:8192
    ds_read_b128 v[76:79], v16 offset:8448
    ds_read_b128 v[80:83], v17 offset:8448
    ds_read_b128 v[84:87], v18 offset:8448
    ds_read_b128 v[88:91], v19 offset:8448
    s_waitcnt lgkmcnt(0)
    s_waitcnt vmcnt(4)
    s_add_u32 m0, s42, 20480
    s_add_u32 s43, s41, 475136
    buffer_load_dwordx4 v10, s[24:27], s43 offen offset:2048 sc0 sc1 nt lds
    buffer_load_dwordx4 v11, s[24:27], s43 offen offset:3072 sc0 sc1 nt lds
    v_mfma_f32_16x16x32_bf16 v[144:147], v[60:63], v[28:31], 0
    v_mfma_f32_16x16x32_bf16 v[144:147], v[64:67], v[32:35], v[144:147]
    v_mfma_f32_16x16x32_bf16 v[144:147], v[68:71], v[36:39], v[144:147]
    v_mfma_f32_16x16x32_bf16 v[144:147], v[72:75], v[40:43], v[144:147]
    v_mfma_f32_16x16x32_bf16 v[144:147], v[76:79], v[44:47], v[144:147]
    v_mfma_f32_16x16x32_bf16 v[144:147], v[80:83], v[48:51], v[144:147]
    v_mfma_f32_16x16x32_bf16 v[144:147], v[84:87], v[52:55], v[144:147]
    v_mfma_f32_16x16x32_bf16 v[144:147], v[88:91], v[56:59], v[144:147]
    v_max3_f32 v232, v232, v140, v141
    v_max3_f32 v232, v232, v142, v143
    s_waitcnt vmcnt(4)
    s_add_u32 m0, s42, 24576
    s_add_u32 s43, s41, 491520
    buffer_load_dwordx4 v4, s[24:27], s43 offen offset:0 sc0 sc1 nt lds
    buffer_load_dwordx4 v5, s[24:27], s43 offen offset:1024 sc0 sc1 nt lds
    s_waitcnt vmcnt(4)
    s_add_u32 m0, s42, 24576
    s_add_u32 s43, s41, 491520
    buffer_load_dwordx4 v6, s[24:27], s43 offen offset:2048 sc0 sc1 nt lds
    buffer_load_dwordx4 v7, s[24:27], s43 offen offset:3072 sc0 sc1 nt lds
    s_waitcnt vmcnt(4)
    s_add_u32 m0, s42, 28672
    s_add_u32 s43, s41, 507904
    buffer_load_dwordx4 v8, s[24:27], s43 offen offset:0 sc0 sc1 nt lds
    buffer_load_dwordx4 v9, s[24:27], s43 offen offset:1024 sc0 sc1 nt lds
    ds_read_b128 v[60:63], v16 offset:16384
    ds_read_b128 v[64:67], v17 offset:16384
    ds_read_b128 v[68:71], v18 offset:16384
    ds_read_b128 v[72:75], v19 offset:16384
    ds_read_b128 v[76:79], v16 offset:16640
    ds_read_b128 v[80:83], v17 offset:16640
    ds_read_b128 v[84:87], v18 offset:16640
    ds_read_b128 v[88:91], v19 offset:16640
    s_waitcnt lgkmcnt(0)
    s_waitcnt vmcnt(4)
    s_add_u32 m0, s42, 28672
    s_add_u32 s43, s41, 507904
    buffer_load_dwordx4 v10, s[24:27], s43 offen offset:2048 sc0 sc1 nt lds
    buffer_load_dwordx4 v11, s[24:27], s43 offen offset:3072 sc0 sc1 nt lds
    v_mfma_f32_16x16x32_bf16 v[148:151], v[60:63], v[28:31], 0
    v_mfma_f32_16x16x32_bf16 v[148:151], v[64:67], v[32:35], v[148:151]
    v_mfma_f32_16x16x32_bf16 v[148:151], v[68:71], v[36:39], v[148:151]
    v_mfma_f32_16x16x32_bf16 v[148:151], v[72:75], v[40:43], v[148:151]
    v_mfma_f32_16x16x32_bf16 v[148:151], v[76:79], v[44:47], v[148:151]
    v_mfma_f32_16x16x32_bf16 v[148:151], v[80:83], v[48:51], v[148:151]
    v_mfma_f32_16x16x32_bf16 v[148:151], v[84:87], v[52:55], v[148:151]
    v_mfma_f32_16x16x32_bf16 v[148:151], v[88:91], v[56:59], v[148:151]
    v_max3_f32 v232, v232, v144, v145
    v_max3_f32 v232, v232, v146, v147
    s_waitcnt vmcnt(4)
    s_add_u32 m0, s42, 0
    s_add_u32 s43, s41, 0
    buffer_load_dwordx4 v12, s[28:31], s43 offen offset:0 sc0 sc1 nt lds
    buffer_load_dwordx4 v13, s[28:31], s43 offen offset:1024 sc0 sc1 nt lds
    s_waitcnt vmcnt(4)
    s_add_u32 m0, s42, 0
    s_add_u32 s43, s41, 0
    buffer_load_dwordx4 v14, s[28:31], s43 offen offset:2048 sc0 sc1 nt lds
    buffer_load_dwordx4 v15, s[28:31], s43 offen offset:3072 sc0 sc1 nt lds
    s_waitcnt vmcnt(4)
    s_add_u32 m0, s42, 4096
    s_add_u32 s43, s41, 16384
    buffer_load_dwordx4 v12, s[28:31], s43 offen offset:0 sc0 sc1 nt lds
    buffer_load_dwordx4 v13, s[28:31], s43 offen offset:1024 sc0 sc1 nt lds
    ds_read_b128 v[60:63], v16 offset:24576
    ds_read_b128 v[64:67], v17 offset:24576
    ds_read_b128 v[68:71], v18 offset:24576
    ds_read_b128 v[72:75], v19 offset:24576
    ds_read_b128 v[76:79], v16 offset:24832
    ds_read_b128 v[80:83], v17 offset:24832
    ds_read_b128 v[84:87], v18 offset:24832
    ds_read_b128 v[88:91], v19 offset:24832
    s_waitcnt lgkmcnt(0)
    s_waitcnt vmcnt(4)
    s_add_u32 m0, s42, 4096
    s_add_u32 s43, s41, 16384
    buffer_load_dwordx4 v14, s[28:31], s43 offen offset:2048 sc0 sc1 nt lds
    buffer_load_dwordx4 v15, s[28:31], s43 offen offset:3072 sc0 sc1 nt lds
    v_mfma_f32_16x16x32_bf16 v[152:155], v[60:63], v[28:31], 0
    v_mfma_f32_16x16x32_bf16 v[152:155], v[64:67], v[32:35], v[152:155]
    v_mfma_f32_16x16x32_bf16 v[152:155], v[68:71], v[36:39], v[152:155]
    v_mfma_f32_16x16x32_bf16 v[152:155], v[72:75], v[40:43], v[152:155]
    v_mfma_f32_16x16x32_bf16 v[152:155], v[76:79], v[44:47], v[152:155]
    v_mfma_f32_16x16x32_bf16 v[152:155], v[80:83], v[48:51], v[152:155]
    v_mfma_f32_16x16x32_bf16 v[152:155], v[84:87], v[52:55], v[152:155]
    v_mfma_f32_16x16x32_bf16 v[152:155], v[88:91], v[56:59], v[152:155]
    v_max3_f32 v232, v232, v148, v149
    v_max3_f32 v232, v232, v150, v151
    s_nop 7
    v_max3_f32 v232, v232, v152, v153
    v_max3_f32 v232, v232, v154, v155
    v_mov_b32 v228, v232
    s_nop 1
    v_permlane16_swap_b32 v232, v228
    s_nop 1
    v_max_f32 v232, v232, v228
    v_mov_b32 v228, v232
    s_nop 1
    v_permlane32_swap_b32 v232, v228
    s_nop 1
    v_max_f32 v232, v232, v228
    v_mul_f32 v233, s44, v232
    s_waitcnt vmcnt(4)
    s_add_u32 m0, s42, 8192
    s_add_u32 s43, s41, 32768
    buffer_load_dwordx4 v12, s[28:31], s43 offen offset:0 sc0 sc1 nt lds
    buffer_load_dwordx4 v13, s[28:31], s43 offen offset:1024 sc0 sc1 nt lds
    s_waitcnt vmcnt(4)
    s_add_u32 m0, s42, 8192
    s_add_u32 s43, s41, 32768
    buffer_load_dwordx4 v14, s[28:31], s43 offen offset:2048 sc0 sc1 nt lds
    buffer_load_dwordx4 v15, s[28:31], s43 offen offset:3072 sc0 sc1 nt lds
    v_fma_f32 v228, v92, s44, -v233
    v_fma_f32 v229, v93, s44, -v233
    v_fma_f32 v230, v94, s44, -v233
    v_fma_f32 v231, v95, s44, -v233
    v_exp_f32 v228, v228
    v_exp_f32 v229, v229
    v_exp_f32 v230, v230
    v_exp_f32 v231, v231
    s_nop 0
    v_cvt_pk_bf16_f32 v226, v228, v229
    v_cvt_pk_bf16_f32 v227, v230, v231
    s_waitcnt vmcnt(4)
    s_add_u32 m0, s42, 12288
    s_add_u32 s43, s41, 49152
    buffer_load_dwordx4 v12, s[28:31], s43 offen offset:0 sc0 sc1 nt lds
    buffer_load_dwordx4 v13, s[28:31], s43 offen offset:1024 sc0 sc1 nt lds
    ds_read_b64_tr_b16 v[60:61], v20 offset:0
    ds_read_b64_tr_b16 v[62:63], v21 offset:0
    ds_read_b64_tr_b16 v[64:65], v22 offset:0
    ds_read_b64_tr_b16 v[66:67], v23 offset:0
    ds_read_b64_tr_b16 v[68:69], v24 offset:0
    ds_read_b64_tr_b16 v[70:71], v25 offset:0
    ds_read_b64_tr_b16 v[72:73], v26 offset:0
    ds_read_b64_tr_b16 v[74:75], v27 offset:0
    ds_read_b64_tr_b16 v[76:77], v20 offset:256
    ds_read_b64_tr_b16 v[78:79], v21 offset:256
    ds_read_b64_tr_b16 v[80:81], v22 offset:256
    ds_read_b64_tr_b16 v[82:83], v23 offset:256
    ds_read_b64_tr_b16 v[84:85], v24 offset:256
    ds_read_b64_tr_b16 v[86:87], v25 offset:256
    ds_read_b64_tr_b16 v[88:89], v26 offset:256
    ds_read_b64_tr_b16 v[90:91], v27 offset:256
    s_waitcnt lgkmcnt(0)
    s_waitcnt vmcnt(4)
    s_add_u32 m0, s42, 12288
    s_add_u32 s43, s41, 49152
    buffer_load_dwordx4 v14, s[28:31], s43 offen offset:2048 sc0 sc1 nt lds
    buffer_load_dwordx4 v15, s[28:31], s43 offen offset:3072 sc0 sc1 nt lds
    v_mfma_f32_16x16x16_bf16 v[220:223], v[226:227], v[224:225], 0
    v_mfma_f32_16x16x16_bf16 v[156:159], v[226:227], v[60:61], 0
    v_mfma_f32_16x16x16_bf16 v[160:163], v[226:227], v[62:63], 0
    v_mfma_f32_16x16x16_bf16 v[164:167], v[226:227], v[64:65], 0
    v_mfma_f32_16x16x16_bf16 v[168:171], v[226:227], v[66:67], 0
    v_mfma_f32_16x16x16_bf16 v[172:175], v[226:227], v[68:69], 0
    v_mfma_f32_16x16x16_bf16 v[176:179], v[226:227], v[70:71], 0
    v_mfma_f32_16x16x16_bf16 v[180:183], v[226:227], v[72:73], 0
    v_mfma_f32_16x16x16_bf16 v[184:187], v[226:227], v[74:75], 0
    s_waitcnt vmcnt(4)
    s_add_u32 m0, s42, 16384
    s_add_u32 s43, s41, 65536
    buffer_load_dwordx4 v12, s[28:31], s43 offen offset:0 sc0 sc1 nt lds
    buffer_load_dwordx4 v13, s[28:31], s43 offen offset:1024 sc0 sc1 nt lds
    v_mfma_f32_16x16x16_bf16 v[188:191], v[226:227], v[76:77], 0
    v_mfma_f32_16x16x16_bf16 v[192:195], v[226:227], v[78:79], 0
    v_mfma_f32_16x16x16_bf16 v[196:199], v[226:227], v[80:81], 0
    v_mfma_f32_16x16x16_bf16 v[200:203], v[226:227], v[82:83], 0
    v_mfma_f32_16x16x16_bf16 v[204:207], v[226:227], v[84:85], 0
    v_mfma_f32_16x16x16_bf16 v[208:211], v[226:227], v[86:87], 0
    v_mfma_f32_16x16x16_bf16 v[212:215], v[226:227], v[88:89], 0
    v_mfma_f32_16x16x16_bf16 v[216:219], v[226:227], v[90:91], 0
    s_waitcnt vmcnt(4)
    s_add_u32 m0, s42, 16384
    s_add_u32 s43, s41, 65536
    buffer_load_dwordx4 v14, s[28:31], s43 offen offset:2048 sc0 sc1 nt lds
    buffer_load_dwordx4 v15, s[28:31], s43 offen offset:3072 sc0 sc1 nt lds
    v_fma_f32 v228, v96, s44, -v233
    v_fma_f32 v229, v97, s44, -v233
    v_fma_f32 v230, v98, s44, -v233
    v_fma_f32 v231, v99, s44, -v233
    v_exp_f32 v228, v228
    v_exp_f32 v229, v229
    v_exp_f32 v230, v230
    v_exp_f32 v231, v231
    s_nop 0
    v_cvt_pk_bf16_f32 v226, v228, v229
    v_cvt_pk_bf16_f32 v227, v230, v231
    s_waitcnt vmcnt(4)
    s_add_u32 m0, s42, 20480
    s_add_u32 s43, s41, 81920
    buffer_load_dwordx4 v12, s[28:31], s43 offen offset:0 sc0 sc1 nt lds
    buffer_load_dwordx4 v13, s[28:31], s43 offen offset:1024 sc0 sc1 nt lds
    ds_read_b64_tr_b16 v[60:61], v20 offset:8192
    ds_read_b64_tr_b16 v[62:63], v21 offset:8192
    ds_read_b64_tr_b16 v[64:65], v22 offset:8192
    ds_read_b64_tr_b16 v[66:67], v23 offset:8192
    ds_read_b64_tr_b16 v[68:69], v24 offset:8192
    ds_read_b64_tr_b16 v[70:71], v25 offset:8192
    ds_read_b64_tr_b16 v[72:73], v26 offset:8192
    ds_read_b64_tr_b16 v[74:75], v27 offset:8192
    ds_read_b64_tr_b16 v[76:77], v20 offset:8448
    ds_read_b64_tr_b16 v[78:79], v21 offset:8448
    ds_read_b64_tr_b16 v[80:81], v22 offset:8448
    ds_read_b64_tr_b16 v[82:83], v23 offset:8448
    ds_read_b64_tr_b16 v[84:85], v24 offset:8448
    ds_read_b64_tr_b16 v[86:87], v25 offset:8448
    ds_read_b64_tr_b16 v[88:89], v26 offset:8448
    ds_read_b64_tr_b16 v[90:91], v27 offset:8448
    s_waitcnt lgkmcnt(0)
    s_waitcnt vmcnt(4)
    s_add_u32 m0, s42, 20480
    s_add_u32 s43, s41, 81920
    buffer_load_dwordx4 v14, s[28:31], s43 offen offset:2048 sc0 sc1 nt lds
    buffer_load_dwordx4 v15, s[28:31], s43 offen offset:3072 sc0 sc1 nt lds
    v_mfma_f32_16x16x16_bf16 v[220:223], v[226:227], v[224:225], v[220:223]
    v_mfma_f32_16x16x16_bf16 v[156:159], v[226:227], v[60:61], v[156:159]
    v_mfma_f32_16x16x16_bf16 v[160:163], v[226:227], v[62:63], v[160:163]
    v_mfma_f32_16x16x16_bf16 v[164:167], v[226:227], v[64:65], v[164:167]
    v_mfma_f32_16x16x16_bf16 v[168:171], v[226:227], v[66:67], v[168:171]
    v_mfma_f32_16x16x16_bf16 v[172:175], v[226:227], v[68:69], v[172:175]
    v_mfma_f32_16x16x16_bf16 v[176:179], v[226:227], v[70:71], v[176:179]
    v_mfma_f32_16x16x16_bf16 v[180:183], v[226:227], v[72:73], v[180:183]
    v_mfma_f32_16x16x16_bf16 v[184:187], v[226:227], v[74:75], v[184:187]
    s_waitcnt vmcnt(4)
    s_add_u32 m0, s42, 24576
    s_add_u32 s43, s41, 98304
    buffer_load_dwordx4 v12, s[28:31], s43 offen offset:0 sc0 sc1 nt lds
    buffer_load_dwordx4 v13, s[28:31], s43 offen offset:1024 sc0 sc1 nt lds
    v_mfma_f32_16x16x16_bf16 v[188:191], v[226:227], v[76:77], v[188:191]
    v_mfma_f32_16x16x16_bf16 v[192:195], v[226:227], v[78:79], v[192:195]
    v_mfma_f32_16x16x16_bf16 v[196:199], v[226:227], v[80:81], v[196:199]
    v_mfma_f32_16x16x16_bf16 v[200:203], v[226:227], v[82:83], v[200:203]
    v_mfma_f32_16x16x16_bf16 v[204:207], v[226:227], v[84:85], v[204:207]
    v_mfma_f32_16x16x16_bf16 v[208:211], v[226:227], v[86:87], v[208:211]
    v_mfma_f32_16x16x16_bf16 v[212:215], v[226:227], v[88:89], v[212:215]
    v_mfma_f32_16x16x16_bf16 v[216:219], v[226:227], v[90:91], v[216:219]
    s_waitcnt vmcnt(4)
    s_add_u32 m0, s42, 24576
    s_add_u32 s43, s41, 98304
    buffer_load_dwordx4 v14, s[28:31], s43 offen offset:2048 sc0 sc1 nt lds
    buffer_load_dwordx4 v15, s[28:31], s43 offen offset:3072 sc0 sc1 nt lds
    v_fma_f32 v228, v100, s44, -v233
    v_fma_f32 v229, v101, s44, -v233
    v_fma_f32 v230, v102, s44, -v233
    v_fma_f32 v231, v103, s44, -v233
    v_exp_f32 v228, v228
    v_exp_f32 v229, v229
    v_exp_f32 v230, v230
    v_exp_f32 v231, v231
    s_nop 0
    v_cvt_pk_bf16_f32 v226, v228, v229
    v_cvt_pk_bf16_f32 v227, v230, v231
    s_waitcnt vmcnt(4)
    s_add_u32 m0, s42, 28672
    s_add_u32 s43, s41, 114688
    buffer_load_dwordx4 v12, s[28:31], s43 offen offset:0 sc0 sc1 nt lds
    buffer_load_dwordx4 v13, s[28:31], s43 offen offset:1024 sc0 sc1 nt lds
    ds_read_b64_tr_b16 v[60:61], v20 offset:16384
    ds_read_b64_tr_b16 v[62:63], v21 offset:16384
    ds_read_b64_tr_b16 v[64:65], v22 offset:16384
    ds_read_b64_tr_b16 v[66:67], v23 offset:16384
    ds_read_b64_tr_b16 v[68:69], v24 offset:16384
    ds_read_b64_tr_b16 v[70:71], v25 offset:16384
    ds_read_b64_tr_b16 v[72:73], v26 offset:16384
    ds_read_b64_tr_b16 v[74:75], v27 offset:16384
    ds_read_b64_tr_b16 v[76:77], v20 offset:16640
    ds_read_b64_tr_b16 v[78:79], v21 offset:16640
    ds_read_b64_tr_b16 v[80:81], v22 offset:16640
    ds_read_b64_tr_b16 v[82:83], v23 offset:16640
    ds_read_b64_tr_b16 v[84:85], v24 offset:16640
    ds_read_b64_tr_b16 v[86:87], v25 offset:16640
    ds_read_b64_tr_b16 v[88:89], v26 offset:16640
    ds_read_b64_tr_b16 v[90:91], v27 offset:16640
    s_waitcnt lgkmcnt(0)
    s_waitcnt vmcnt(4)
    s_add_u32 m0, s42, 28672
    s_add_u32 s43, s41, 114688
    buffer_load_dwordx4 v14, s[28:31], s43 offen offset:2048 sc0 sc1 nt lds
    buffer_load_dwordx4 v15, s[28:31], s43 offen offset:3072 sc0 sc1 nt lds
    v_mfma_f32_16x16x16_bf16 v[220:223], v[226:227], v[224:225], v[220:223]
    v_mfma_f32_16x16x16_bf16 v[156:159], v[226:227], v[60:61], v[156:159]
    v_mfma_f32_16x16x16_bf16 v[160:163], v[226:227], v[62:63], v[160:163]
    v_mfma_f32_16x16x16_bf16 v[164:167], v[226:227], v[64:65], v[164:167]
    v_mfma_f32_16x16x16_bf16 v[168:171], v[226:227], v[66:67], v[168:171]
    v_mfma_f32_16x16x16_bf16 v[172:175], v[226:227], v[68:69], v[172:175]
    v_mfma_f32_16x16x16_bf16 v[176:179], v[226:227], v[70:71], v[176:179]
    v_mfma_f32_16x16x16_bf16 v[180:183], v[226:227], v[72:73], v[180:183]
    v_mfma_f32_16x16x16_bf16 v[184:187], v[226:227], v[74:75], v[184:187]
    s_waitcnt vmcnt(4)
    s_add_u32 m0, s42, 0
    s_add_u32 s43, s41, 131072
    buffer_load_dwordx4 v12, s[28:31], s43 offen offset:0 sc0 sc1 nt lds
    buffer_load_dwordx4 v13, s[28:31], s43 offen offset:1024 sc0 sc1 nt lds
    v_mfma_f32_16x16x16_bf16 v[188:191], v[226:227], v[76:77], v[188:191]
    v_mfma_f32_16x16x16_bf16 v[192:195], v[226:227], v[78:79], v[192:195]
    v_mfma_f32_16x16x16_bf16 v[196:199], v[226:227], v[80:81], v[196:199]
    v_mfma_f32_16x16x16_bf16 v[200:203], v[226:227], v[82:83], v[200:203]
    v_mfma_f32_16x16x16_bf16 v[204:207], v[226:227], v[84:85], v[204:207]
    v_mfma_f32_16x16x16_bf16 v[208:211], v[226:227], v[86:87], v[208:211]
    v_mfma_f32_16x16x16_bf16 v[212:215], v[226:227], v[88:89], v[212:215]
    v_mfma_f32_16x16x16_bf16 v[216:219], v[226:227], v[90:91], v[216:219]
    s_waitcnt vmcnt(4)
    s_add_u32 m0, s42, 0
    s_add_u32 s43, s41, 131072
    buffer_load_dwordx4 v14, s[28:31], s43 offen offset:2048 sc0 sc1 nt lds
    buffer_load_dwordx4 v15, s[28:31], s43 offen offset:3072 sc0 sc1 nt lds
    v_fma_f32 v228, v104, s44, -v233
    v_fma_f32 v229, v105, s44, -v233
    v_fma_f32 v230, v106, s44, -v233
    v_fma_f32 v231, v107, s44, -v233
    v_exp_f32 v228, v228
    v_exp_f32 v229, v229
    v_exp_f32 v230, v230
    v_exp_f32 v231, v231
    s_nop 0
    v_cvt_pk_bf16_f32 v226, v228, v229
    v_cvt_pk_bf16_f32 v227, v230, v231
    s_waitcnt vmcnt(4)
    s_add_u32 m0, s42, 4096
    s_add_u32 s43, s41, 147456
    buffer_load_dwordx4 v12, s[28:31], s43 offen offset:0 sc0 sc1 nt lds
    buffer_load_dwordx4 v13, s[28:31], s43 offen offset:1024 sc0 sc1 nt lds
    ds_read_b64_tr_b16 v[60:61], v20 offset:24576
    ds_read_b64_tr_b16 v[62:63], v21 offset:24576
    ds_read_b64_tr_b16 v[64:65], v22 offset:24576
    ds_read_b64_tr_b16 v[66:67], v23 offset:24576
    ds_read_b64_tr_b16 v[68:69], v24 offset:24576
    ds_read_b64_tr_b16 v[70:71], v25 offset:24576
    ds_read_b64_tr_b16 v[72:73], v26 offset:24576
    ds_read_b64_tr_b16 v[74:75], v27 offset:24576
    ds_read_b64_tr_b16 v[76:77], v20 offset:24832
    ds_read_b64_tr_b16 v[78:79], v21 offset:24832
    ds_read_b64_tr_b16 v[80:81], v22 offset:24832
    ds_read_b64_tr_b16 v[82:83], v23 offset:24832
    ds_read_b64_tr_b16 v[84:85], v24 offset:24832
    ds_read_b64_tr_b16 v[86:87], v25 offset:24832
    ds_read_b64_tr_b16 v[88:89], v26 offset:24832
    ds_read_b64_tr_b16 v[90:91], v27 offset:24832
    s_waitcnt lgkmcnt(0)
    s_waitcnt vmcnt(4)
    s_add_u32 m0, s42, 4096
    s_add_u32 s43, s41, 147456
    buffer_load_dwordx4 v14, s[28:31], s43 offen offset:2048 sc0 sc1 nt lds
    buffer_load_dwordx4 v15, s[28:31], s43 offen offset:3072 sc0 sc1 nt lds
    v_mfma_f32_16x16x16_bf16 v[220:223], v[226:227], v[224:225], v[220:223]
    v_mfma_f32_16x16x16_bf16 v[156:159], v[226:227], v[60:61], v[156:159]
    v_mfma_f32_16x16x16_bf16 v[160:163], v[226:227], v[62:63], v[160:163]
    v_mfma_f32_16x16x16_bf16 v[164:167], v[226:227], v[64:65], v[164:167]
    v_mfma_f32_16x16x16_bf16 v[168:171], v[226:227], v[66:67], v[168:171]
    v_mfma_f32_16x16x16_bf16 v[172:175], v[226:227], v[68:69], v[172:175]
    v_mfma_f32_16x16x16_bf16 v[176:179], v[226:227], v[70:71], v[176:179]
    v_mfma_f32_16x16x16_bf16 v[180:183], v[226:227], v[72:73], v[180:183]
    v_mfma_f32_16x16x16_bf16 v[184:187], v[226:227], v[74:75], v[184:187]
    s_waitcnt vmcnt(4)
    s_add_u32 m0, s42, 8192
    s_add_u32 s43, s41, 163840
    buffer_load_dwordx4 v12, s[28:31], s43 offen offset:0 sc0 sc1 nt lds
    buffer_load_dwordx4 v13, s[28:31], s43 offen offset:1024 sc0 sc1 nt lds
    v_mfma_f32_16x16x16_bf16 v[188:191], v[226:227], v[76:77], v[188:191]
    v_mfma_f32_16x16x16_bf16 v[192:195], v[226:227], v[78:79], v[192:195]
    v_mfma_f32_16x16x16_bf16 v[196:199], v[226:227], v[80:81], v[196:199]
    v_mfma_f32_16x16x16_bf16 v[200:203], v[226:227], v[82:83], v[200:203]
    v_mfma_f32_16x16x16_bf16 v[204:207], v[226:227], v[84:85], v[204:207]
    v_mfma_f32_16x16x16_bf16 v[208:211], v[226:227], v[86:87], v[208:211]
    v_mfma_f32_16x16x16_bf16 v[212:215], v[226:227], v[88:89], v[212:215]
    v_mfma_f32_16x16x16_bf16 v[216:219], v[226:227], v[90:91], v[216:219]
    s_waitcnt vmcnt(4)
    s_add_u32 m0, s42, 8192
    s_add_u32 s43, s41, 163840
    buffer_load_dwordx4 v14, s[28:31], s43 offen offset:2048 sc0 sc1 nt lds
    buffer_load_dwordx4 v15, s[28:31], s43 offen offset:3072 sc0 sc1 nt lds
    v_fma_f32 v228, v108, s44, -v233
    v_fma_f32 v229, v109, s44, -v233
    v_fma_f32 v230, v110, s44, -v233
    v_fma_f32 v231, v111, s44, -v233
    v_exp_f32 v228, v228
    v_exp_f32 v229, v229
    v_exp_f32 v230, v230
    v_exp_f32 v231, v231
    s_nop 0
    v_cvt_pk_bf16_f32 v226, v228, v229
    v_cvt_pk_bf16_f32 v227, v230, v231
    s_waitcnt vmcnt(4)
    s_add_u32 m0, s42, 12288
    s_add_u32 s43, s41, 180224
    buffer_load_dwordx4 v12, s[28:31], s43 offen offset:0 sc0 sc1 nt lds
    buffer_load_dwordx4 v13, s[28:31], s43 offen offset:1024 sc0 sc1 nt lds
    ds_read_b64_tr_b16 v[60:61], v20 offset:0
    ds_read_b64_tr_b16 v[62:63], v21 offset:0
    ds_read_b64_tr_b16 v[64:65], v22 offset:0
    ds_read_b64_tr_b16 v[66:67], v23 offset:0
    ds_read_b64_tr_b16 v[68:69], v24 offset:0
    ds_read_b64_tr_b16 v[70:71], v25 offset:0
    ds_read_b64_tr_b16 v[72:73], v26 offset:0
    ds_read_b64_tr_b16 v[74:75], v27 offset:0
    ds_read_b64_tr_b16 v[76:77], v20 offset:256
    ds_read_b64_tr_b16 v[78:79], v21 offset:256
    ds_read_b64_tr_b16 v[80:81], v22 offset:256
    ds_read_b64_tr_b16 v[82:83], v23 offset:256
    ds_read_b64_tr_b16 v[84:85], v24 offset:256
    ds_read_b64_tr_b16 v[86:87], v25 offset:256
    ds_read_b64_tr_b16 v[88:89], v26 offset:256
    ds_read_b64_tr_b16 v[90:91], v27 offset:256
    s_waitcnt lgkmcnt(0)
    s_waitcnt vmcnt(4)
    s_add_u32 m0, s42, 12288
    s_add_u32 s43, s41, 180224
    buffer_load_dwordx4 v14, s[28:31], s43 offen offset:2048 sc0 sc1 nt lds
    buffer_load_dwordx4 v15, s[28:31], s43 offen offset:3072 sc0 sc1 nt lds
    v_mfma_f32_16x16x16_bf16 v[220:223], v[226:227], v[224:225], v[220:223]
    v_mfma_f32_16x16x16_bf16 v[156:159], v[226:227], v[60:61], v[156:159]
    v_mfma_f32_16x16x16_bf16 v[160:163], v[226:227], v[62:63], v[160:163]
    v_mfma_f32_16x16x16_bf16 v[164:167], v[226:227], v[64:65], v[164:167]
    v_mfma_f32_16x16x16_bf16 v[168:171], v[226:227], v[66:67], v[168:171]
    v_mfma_f32_16x16x16_bf16 v[172:175], v[226:227], v[68:69], v[172:175]
    v_mfma_f32_16x16x16_bf16 v[176:179], v[226:227], v[70:71], v[176:179]
    v_mfma_f32_16x16x16_bf16 v[180:183], v[226:227], v[72:73], v[180:183]
    v_mfma_f32_16x16x16_bf16 v[184:187], v[226:227], v[74:75], v[184:187]
    s_waitcnt vmcnt(4)
    s_add_u32 m0, s42, 16384
    s_add_u32 s43, s41, 196608
    buffer_load_dwordx4 v12, s[28:31], s43 offen offset:0 sc0 sc1 nt lds
    buffer_load_dwordx4 v13, s[28:31], s43 offen offset:1024 sc0 sc1 nt lds
    v_mfma_f32_16x16x16_bf16 v[188:191], v[226:227], v[76:77], v[188:191]
    v_mfma_f32_16x16x16_bf16 v[192:195], v[226:227], v[78:79], v[192:195]
    v_mfma_f32_16x16x16_bf16 v[196:199], v[226:227], v[80:81], v[196:199]
    v_mfma_f32_16x16x16_bf16 v[200:203], v[226:227], v[82:83], v[200:203]
    v_mfma_f32_16x16x16_bf16 v[204:207], v[226:227], v[84:85], v[204:207]
    v_mfma_f32_16x16x16_bf16 v[208:211], v[226:227], v[86:87], v[208:211]
    v_mfma_f32_16x16x16_bf16 v[212:215], v[226:227], v[88:89], v[212:215]
    v_mfma_f32_16x16x16_bf16 v[216:219], v[226:227], v[90:91], v[216:219]
    s_waitcnt vmcnt(4)
    s_add_u32 m0, s42, 16384
    s_add_u32 s43, s41, 196608
    buffer_load_dwordx4 v14, s[28:31], s43 offen offset:2048 sc0 sc1 nt lds
    buffer_load_dwordx4 v15, s[28:31], s43 offen offset:3072 sc0 sc1 nt lds
    v_fma_f32 v228, v112, s44, -v233
    v_fma_f32 v229, v113, s44, -v233
    v_fma_f32 v230, v114, s44, -v233
    v_fma_f32 v231, v115, s44, -v233
    v_exp_f32 v228, v228
    v_exp_f32 v229, v229
    v_exp_f32 v230, v230
    v_exp_f32 v231, v231
    s_nop 0
    v_cvt_pk_bf16_f32 v226, v228, v229
    v_cvt_pk_bf16_f32 v227, v230, v231
    s_waitcnt vmcnt(4)
    s_add_u32 m0, s42, 20480
    s_add_u32 s43, s41, 212992
    buffer_load_dwordx4 v12, s[28:31], s43 offen offset:0 sc0 sc1 nt lds
    buffer_load_dwordx4 v13, s[28:31], s43 offen offset:1024 sc0 sc1 nt lds
    ds_read_b64_tr_b16 v[60:61], v20 offset:8192
    ds_read_b64_tr_b16 v[62:63], v21 offset:8192
    ds_read_b64_tr_b16 v[64:65], v22 offset:8192
    ds_read_b64_tr_b16 v[66:67], v23 offset:8192
    ds_read_b64_tr_b16 v[68:69], v24 offset:8192
    ds_read_b64_tr_b16 v[70:71], v25 offset:8192
    ds_read_b64_tr_b16 v[72:73], v26 offset:8192
    ds_read_b64_tr_b16 v[74:75], v27 offset:8192
    ds_read_b64_tr_b16 v[76:77], v20 offset:8448
    ds_read_b64_tr_b16 v[78:79], v21 offset:8448
    ds_read_b64_tr_b16 v[80:81], v22 offset:8448
    ds_read_b64_tr_b16 v[82:83], v23 offset:8448
    ds_read_b64_tr_b16 v[84:85], v24 offset:8448
    ds_read_b64_tr_b16 v[86:87], v25 offset:8448
    ds_read_b64_tr_b16 v[88:89], v26 offset:8448
    ds_read_b64_tr_b16 v[90:91], v27 offset:8448
    s_waitcnt lgkmcnt(0)
    s_waitcnt vmcnt(4)
    s_add_u32 m0, s42, 20480
    s_add_u32 s43, s41, 212992
    buffer_load_dwordx4 v14, s[28:31], s43 offen offset:2048 sc0 sc1 nt lds
    buffer_load_dwordx4 v15, s[28:31], s43 offen offset:3072 sc0 sc1 nt lds
    v_mfma_f32_16x16x16_bf16 v[220:223], v[226:227], v[224:225], v[220:223]
    v_mfma_f32_16x16x16_bf16 v[156:159], v[226:227], v[60:61], v[156:159]
    v_mfma_f32_16x16x16_bf16 v[160:163], v[226:227], v[62:63], v[160:163]
    v_mfma_f32_16x16x16_bf16 v[164:167], v[226:227], v[64:65], v[164:167]
    v_mfma_f32_16x16x16_bf16 v[168:171], v[226:227], v[66:67], v[168:171]
    v_mfma_f32_16x16x16_bf16 v[172:175], v[226:227], v[68:69], v[172:175]
    v_mfma_f32_16x16x16_bf16 v[176:179], v[226:227], v[70:71], v[176:179]
    v_mfma_f32_16x16x16_bf16 v[180:183], v[226:227], v[72:73], v[180:183]
    v_mfma_f32_16x16x16_bf16 v[184:187], v[226:227], v[74:75], v[184:187]
    s_waitcnt vmcnt(4)
    s_add_u32 m0, s42, 24576
    s_add_u32 s43, s41, 229376
    buffer_load_dwordx4 v12, s[28:31], s43 offen offset:0 sc0 sc1 nt lds
    buffer_load_dwordx4 v13, s[28:31], s43 offen offset:1024 sc0 sc1 nt lds
    v_mfma_f32_16x16x16_bf16 v[188:191], v[226:227], v[76:77], v[188:191]
    v_mfma_f32_16x16x16_bf16 v[192:195], v[226:227], v[78:79], v[192:195]
    v_mfma_f32_16x16x16_bf16 v[196:199], v[226:227], v[80:81], v[196:199]
    v_mfma_f32_16x16x16_bf16 v[200:203], v[226:227], v[82:83], v[200:203]
    v_mfma_f32_16x16x16_bf16 v[204:207], v[226:227], v[84:85], v[204:207]
    v_mfma_f32_16x16x16_bf16 v[208:211], v[226:227], v[86:87], v[208:211]
    v_mfma_f32_16x16x16_bf16 v[212:215], v[226:227], v[88:89], v[212:215]
    v_mfma_f32_16x16x16_bf16 v[216:219], v[226:227], v[90:91], v[216:219]
    s_waitcnt vmcnt(4)
    s_add_u32 m0, s42, 24576
    s_add_u32 s43, s41, 229376
    buffer_load_dwordx4 v14, s[28:31], s43 offen offset:2048 sc0 sc1 nt lds
    buffer_load_dwordx4 v15, s[28:31], s43 offen offset:3072 sc0 sc1 nt lds
    v_fma_f32 v228, v116, s44, -v233
    v_fma_f32 v229, v117, s44, -v233
    v_fma_f32 v230, v118, s44, -v233
    v_fma_f32 v231, v119, s44, -v233
    v_exp_f32 v228, v228
    v_exp_f32 v229, v229
    v_exp_f32 v230, v230
    v_exp_f32 v231, v231
    s_nop 0
    v_cvt_pk_bf16_f32 v226, v228, v229
    v_cvt_pk_bf16_f32 v227, v230, v231
    s_waitcnt vmcnt(4)
    s_add_u32 m0, s42, 28672
    s_add_u32 s43, s41, 245760
    buffer_load_dwordx4 v12, s[28:31], s43 offen offset:0 sc0 sc1 nt lds
    buffer_load_dwordx4 v13, s[28:31], s43 offen offset:1024 sc0 sc1 nt lds
    ds_read_b64_tr_b16 v[60:61], v20 offset:16384
    ds_read_b64_tr_b16 v[62:63], v21 offset:16384
    ds_read_b64_tr_b16 v[64:65], v22 offset:16384
    ds_read_b64_tr_b16 v[66:67], v23 offset:16384
    ds_read_b64_tr_b16 v[68:69], v24 offset:16384
    ds_read_b64_tr_b16 v[70:71], v25 offset:16384
    ds_read_b64_tr_b16 v[72:73], v26 offset:16384
    ds_read_b64_tr_b16 v[74:75], v27 offset:16384
    ds_read_b64_tr_b16 v[76:77], v20 offset:16640
    ds_read_b64_tr_b16 v[78:79], v21 offset:16640
    ds_read_b64_tr_b16 v[80:81], v22 offset:16640
    ds_read_b64_tr_b16 v[82:83], v23 offset:16640
    ds_read_b64_tr_b16 v[84:85], v24 offset:16640
    ds_read_b64_tr_b16 v[86:87], v25 offset:16640
    ds_read_b64_tr_b16 v[88:89], v26 offset:16640
    ds_read_b64_tr_b16 v[90:91], v27 offset:16640
    s_waitcnt lgkmcnt(0)
    s_waitcnt vmcnt(4)
    s_add_u32 m0, s42, 28672
    s_add_u32 s43, s41, 245760
    buffer_load_dwordx4 v14, s[28:31], s43 offen offset:2048 sc0 sc1 nt lds
    buffer_load_dwordx4 v15, s[28:31], s43 offen offset:3072 sc0 sc1 nt lds
    v_mfma_f32_16x16x16_bf16 v[220:223], v[226:227], v[224:225], v[220:223]
    v_mfma_f32_16x16x16_bf16 v[156:159], v[226:227], v[60:61], v[156:159]
    v_mfma_f32_16x16x16_bf16 v[160:163], v[226:227], v[62:63], v[160:163]
    v_mfma_f32_16x16x16_bf16 v[164:167], v[226:227], v[64:65], v[164:167]
    v_mfma_f32_16x16x16_bf16 v[168:171], v[226:227], v[66:67], v[168:171]
    v_mfma_f32_16x16x16_bf16 v[172:175], v[226:227], v[68:69], v[172:175]
    v_mfma_f32_16x16x16_bf16 v[176:179], v[226:227], v[70:71], v[176:179]
    v_mfma_f32_16x16x16_bf16 v[180:183], v[226:227], v[72:73], v[180:183]
    v_mfma_f32_16x16x16_bf16 v[184:187], v[226:227], v[74:75], v[184:187]
    s_waitcnt vmcnt(4)
    s_add_u32 m0, s42, 0
    s_add_u32 s43, s41, 262144
    buffer_load_dwordx4 v12, s[28:31], s43 offen offset:0 sc0 sc1 nt lds
    buffer_load_dwordx4 v13, s[28:31], s43 offen offset:1024 sc0 sc1 nt lds
    v_mfma_f32_16x16x16_bf16 v[188:191], v[226:227], v[76:77], v[188:191]
    v_mfma_f32_16x16x16_bf16 v[192:195], v[226:227], v[78:79], v[192:195]
    v_mfma_f32_16x16x16_bf16 v[196:199], v[226:227], v[80:81], v[196:199]
    v_mfma_f32_16x16x16_bf16 v[200:203], v[226:227], v[82:83], v[200:203]
    v_mfma_f32_16x16x16_bf16 v[204:207], v[226:227], v[84:85], v[204:207]
    v_mfma_f32_16x16x16_bf16 v[208:211], v[226:227], v[86:87], v[208:211]
    v_mfma_f32_16x16x16_bf16 v[212:215], v[226:227], v[88:89], v[212:215]
    v_mfma_f32_16x16x16_bf16 v[216:219], v[226:227], v[90:91], v[216:219]
    s_waitcnt vmcnt(4)
    s_add_u32 m0, s42, 0
    s_add_u32 s43, s41, 262144
    buffer_load_dwordx4 v14, s[28:31], s43 offen offset:2048 sc0 sc1 nt lds
    buffer_load_dwordx4 v15, s[28:31], s43 offen offset:3072 sc0 sc1 nt lds
    v_fma_f32 v228, v120, s44, -v233
    v_fma_f32 v229, v121, s44, -v233
    v_fma_f32 v230, v122, s44, -v233
    v_fma_f32 v231, v123, s44, -v233
    v_exp_f32 v228, v228
    v_exp_f32 v229, v229
    v_exp_f32 v230, v230
    v_exp_f32 v231, v231
    s_nop 0
    v_cvt_pk_bf16_f32 v226, v228, v229
    v_cvt_pk_bf16_f32 v227, v230, v231
    s_waitcnt vmcnt(4)
    s_add_u32 m0, s42, 4096
    s_add_u32 s43, s41, 278528
    buffer_load_dwordx4 v12, s[28:31], s43 offen offset:0 sc0 sc1 nt lds
    buffer_load_dwordx4 v13, s[28:31], s43 offen offset:1024 sc0 sc1 nt lds
    ds_read_b64_tr_b16 v[60:61], v20 offset:24576
    ds_read_b64_tr_b16 v[62:63], v21 offset:24576
    ds_read_b64_tr_b16 v[64:65], v22 offset:24576
    ds_read_b64_tr_b16 v[66:67], v23 offset:24576
    ds_read_b64_tr_b16 v[68:69], v24 offset:24576
    ds_read_b64_tr_b16 v[70:71], v25 offset:24576
    ds_read_b64_tr_b16 v[72:73], v26 offset:24576
    ds_read_b64_tr_b16 v[74:75], v27 offset:24576
    ds_read_b64_tr_b16 v[76:77], v20 offset:24832
    ds_read_b64_tr_b16 v[78:79], v21 offset:24832
    ds_read_b64_tr_b16 v[80:81], v22 offset:24832
    ds_read_b64_tr_b16 v[82:83], v23 offset:24832
    ds_read_b64_tr_b16 v[84:85], v24 offset:24832
    ds_read_b64_tr_b16 v[86:87], v25 offset:24832
    ds_read_b64_tr_b16 v[88:89], v26 offset:24832
    ds_read_b64_tr_b16 v[90:91], v27 offset:24832
    s_waitcnt lgkmcnt(0)
    s_waitcnt vmcnt(4)
    s_add_u32 m0, s42, 4096
    s_add_u32 s43, s41, 278528
    buffer_load_dwordx4 v14, s[28:31], s43 offen offset:2048 sc0 sc1 nt lds
    buffer_load_dwordx4 v15, s[28:31], s43 offen offset:3072 sc0 sc1 nt lds
    v_mfma_f32_16x16x16_bf16 v[220:223], v[226:227], v[224:225], v[220:223]
    v_mfma_f32_16x16x16_bf16 v[156:159], v[226:227], v[60:61], v[156:159]
    v_mfma_f32_16x16x16_bf16 v[160:163], v[226:227], v[62:63], v[160:163]
    v_mfma_f32_16x16x16_bf16 v[164:167], v[226:227], v[64:65], v[164:167]
    v_mfma_f32_16x16x16_bf16 v[168:171], v[226:227], v[66:67], v[168:171]
    v_mfma_f32_16x16x16_bf16 v[172:175], v[226:227], v[68:69], v[172:175]
    v_mfma_f32_16x16x16_bf16 v[176:179], v[226:227], v[70:71], v[176:179]
    v_mfma_f32_16x16x16_bf16 v[180:183], v[226:227], v[72:73], v[180:183]
    v_mfma_f32_16x16x16_bf16 v[184:187], v[226:227], v[74:75], v[184:187]
    s_waitcnt vmcnt(4)
    s_add_u32 m0, s42, 8192
    s_add_u32 s43, s41, 294912
    buffer_load_dwordx4 v12, s[28:31], s43 offen offset:0 sc0 sc1 nt lds
    buffer_load_dwordx4 v13, s[28:31], s43 offen offset:1024 sc0 sc1 nt lds
    v_mfma_f32_16x16x16_bf16 v[188:191], v[226:227], v[76:77], v[188:191]
    v_mfma_f32_16x16x16_bf16 v[192:195], v[226:227], v[78:79], v[192:195]
    v_mfma_f32_16x16x16_bf16 v[196:199], v[226:227], v[80:81], v[196:199]
    v_mfma_f32_16x16x16_bf16 v[200:203], v[226:227], v[82:83], v[200:203]
    v_mfma_f32_16x16x16_bf16 v[204:207], v[226:227], v[84:85], v[204:207]
    v_mfma_f32_16x16x16_bf16 v[208:211], v[226:227], v[86:87], v[208:211]
    v_mfma_f32_16x16x16_bf16 v[212:215], v[226:227], v[88:89], v[212:215]
    v_mfma_f32_16x16x16_bf16 v[216:219], v[226:227], v[90:91], v[216:219]
    s_waitcnt vmcnt(4)
    s_add_u32 m0, s42, 8192
    s_add_u32 s43, s41, 294912
    buffer_load_dwordx4 v14, s[28:31], s43 offen offset:2048 sc0 sc1 nt lds
    buffer_load_dwordx4 v15, s[28:31], s43 offen offset:3072 sc0 sc1 nt lds
    v_fma_f32 v228, v124, s44, -v233
    v_fma_f32 v229, v125, s44, -v233
    v_fma_f32 v230, v126, s44, -v233
    v_fma_f32 v231, v127, s44, -v233
    v_exp_f32 v228, v228
    v_exp_f32 v229, v229
    v_exp_f32 v230, v230
    v_exp_f32 v231, v231
    s_nop 0
    v_cvt_pk_bf16_f32 v226, v228, v229
    v_cvt_pk_bf16_f32 v227, v230, v231
    s_waitcnt vmcnt(4)
    s_add_u32 m0, s42, 12288
    s_add_u32 s43, s41, 311296
    buffer_load_dwordx4 v12, s[28:31], s43 offen offset:0 sc0 sc1 nt lds
    buffer_load_dwordx4 v13, s[28:31], s43 offen offset:1024 sc0 sc1 nt lds
    ds_read_b64_tr_b16 v[60:61], v20 offset:0
    ds_read_b64_tr_b16 v[62:63], v21 offset:0
    ds_read_b64_tr_b16 v[64:65], v22 offset:0
    ds_read_b64_tr_b16 v[66:67], v23 offset:0
    ds_read_b64_tr_b16 v[68:69], v24 offset:0
    ds_read_b64_tr_b16 v[70:71], v25 offset:0
    ds_read_b64_tr_b16 v[72:73], v26 offset:0
    ds_read_b64_tr_b16 v[74:75], v27 offset:0
    ds_read_b64_tr_b16 v[76:77], v20 offset:256
    ds_read_b64_tr_b16 v[78:79], v21 offset:256
    ds_read_b64_tr_b16 v[80:81], v22 offset:256
    ds_read_b64_tr_b16 v[82:83], v23 offset:256
    ds_read_b64_tr_b16 v[84:85], v24 offset:256
    ds_read_b64_tr_b16 v[86:87], v25 offset:256
    ds_read_b64_tr_b16 v[88:89], v26 offset:256
    ds_read_b64_tr_b16 v[90:91], v27 offset:256
    s_waitcnt lgkmcnt(0)
    s_waitcnt vmcnt(4)
    s_add_u32 m0, s42, 12288
    s_add_u32 s43, s41, 311296
    buffer_load_dwordx4 v14, s[28:31], s43 offen offset:2048 sc0 sc1 nt lds
    buffer_load_dwordx4 v15, s[28:31], s43 offen offset:3072 sc0 sc1 nt lds
    v_mfma_f32_16x16x16_bf16 v[220:223], v[226:227], v[224:225], v[220:223]
    v_mfma_f32_16x16x16_bf16 v[156:159], v[226:227], v[60:61], v[156:159]
    v_mfma_f32_16x16x16_bf16 v[160:163], v[226:227], v[62:63], v[160:163]
    v_mfma_f32_16x16x16_bf16 v[164:167], v[226:227], v[64:65], v[164:167]
    v_mfma_f32_16x16x16_bf16 v[168:171], v[226:227], v[66:67], v[168:171]
    v_mfma_f32_16x16x16_bf16 v[172:175], v[226:227], v[68:69], v[172:175]
    v_mfma_f32_16x16x16_bf16 v[176:179], v[226:227], v[70:71], v[176:179]
    v_mfma_f32_16x16x16_bf16 v[180:183], v[226:227], v[72:73], v[180:183]
    v_mfma_f32_16x16x16_bf16 v[184:187], v[226:227], v[74:75], v[184:187]
    s_waitcnt vmcnt(4)
    s_add_u32 m0, s42, 16384
    s_add_u32 s43, s41, 327680
    buffer_load_dwordx4 v12, s[28:31], s43 offen offset:0 sc0 sc1 nt lds
    buffer_load_dwordx4 v13, s[28:31], s43 offen offset:1024 sc0 sc1 nt lds
    v_mfma_f32_16x16x16_bf16 v[188:191], v[226:227], v[76:77], v[188:191]
    v_mfma_f32_16x16x16_bf16 v[192:195], v[226:227], v[78:79], v[192:195]
    v_mfma_f32_16x16x16_bf16 v[196:199], v[226:227], v[80:81], v[196:199]
    v_mfma_f32_16x16x16_bf16 v[200:203], v[226:227], v[82:83], v[200:203]
    v_mfma_f32_16x16x16_bf16 v[204:207], v[226:227], v[84:85], v[204:207]
    v_mfma_f32_16x16x16_bf16 v[208:211], v[226:227], v[86:87], v[208:211]
    v_mfma_f32_16x16x16_bf16 v[212:215], v[226:227], v[88:89], v[212:215]
    v_mfma_f32_16x16x16_bf16 v[216:219], v[226:227], v[90:91], v[216:219]
    s_waitcnt vmcnt(4)
    s_add_u32 m0, s42, 16384
    s_add_u32 s43, s41, 327680
    buffer_load_dwordx4 v14, s[28:31], s43 offen offset:2048 sc0 sc1 nt lds
    buffer_load_dwordx4 v15, s[28:31], s43 offen offset:3072 sc0 sc1 nt lds
    v_fma_f32 v228, v128, s44, -v233
    v_fma_f32 v229, v129, s44, -v233
    v_fma_f32 v230, v130, s44, -v233
    v_fma_f32 v231, v131, s44, -v233
    v_exp_f32 v228, v228
    v_exp_f32 v229, v229
    v_exp_f32 v230, v230
    v_exp_f32 v231, v231
    s_nop 0
    v_cvt_pk_bf16_f32 v226, v228, v229
    v_cvt_pk_bf16_f32 v227, v230, v231
    s_waitcnt vmcnt(4)
    s_add_u32 m0, s42, 20480
    s_add_u32 s43, s41, 344064
    buffer_load_dwordx4 v12, s[28:31], s43 offen offset:0 sc0 sc1 nt lds
    buffer_load_dwordx4 v13, s[28:31], s43 offen offset:1024 sc0 sc1 nt lds
    ds_read_b64_tr_b16 v[60:61], v20 offset:8192
    ds_read_b64_tr_b16 v[62:63], v21 offset:8192
    ds_read_b64_tr_b16 v[64:65], v22 offset:8192
    ds_read_b64_tr_b16 v[66:67], v23 offset:8192
    ds_read_b64_tr_b16 v[68:69], v24 offset:8192
    ds_read_b64_tr_b16 v[70:71], v25 offset:8192
    ds_read_b64_tr_b16 v[72:73], v26 offset:8192
    ds_read_b64_tr_b16 v[74:75], v27 offset:8192
    ds_read_b64_tr_b16 v[76:77], v20 offset:8448
    ds_read_b64_tr_b16 v[78:79], v21 offset:8448
    ds_read_b64_tr_b16 v[80:81], v22 offset:8448
    ds_read_b64_tr_b16 v[82:83], v23 offset:8448
    ds_read_b64_tr_b16 v[84:85], v24 offset:8448
    ds_read_b64_tr_b16 v[86:87], v25 offset:8448
    ds_read_b64_tr_b16 v[88:89], v26 offset:8448
    ds_read_b64_tr_b16 v[90:91], v27 offset:8448
    s_waitcnt lgkmcnt(0)
    s_waitcnt vmcnt(4)
    s_add_u32 m0, s42, 20480
    s_add_u32 s43, s41, 344064
    buffer_load_dwordx4 v14, s[28:31], s43 offen offset:2048 sc0 sc1 nt lds
    buffer_load_dwordx4 v15, s[28:31], s43 offen offset:3072 sc0 sc1 nt lds
    v_mfma_f32_16x16x16_bf16 v[220:223], v[226:227], v[224:225], v[220:223]
    v_mfma_f32_16x16x16_bf16 v[156:159], v[226:227], v[60:61], v[156:159]
    v_mfma_f32_16x16x16_bf16 v[160:163], v[226:227], v[62:63], v[160:163]
    v_mfma_f32_16x16x16_bf16 v[164:167], v[226:227], v[64:65], v[164:167]
    v_mfma_f32_16x16x16_bf16 v[168:171], v[226:227], v[66:67], v[168:171]
    v_mfma_f32_16x16x16_bf16 v[172:175], v[226:227], v[68:69], v[172:175]
    v_mfma_f32_16x16x16_bf16 v[176:179], v[226:227], v[70:71], v[176:179]
    v_mfma_f32_16x16x16_bf16 v[180:183], v[226:227], v[72:73], v[180:183]
    v_mfma_f32_16x16x16_bf16 v[184:187], v[226:227], v[74:75], v[184:187]
    s_waitcnt vmcnt(4)
    s_add_u32 m0, s42, 24576
    s_add_u32 s43, s41, 360448
    buffer_load_dwordx4 v12, s[28:31], s43 offen offset:0 sc0 sc1 nt lds
    buffer_load_dwordx4 v13, s[28:31], s43 offen offset:1024 sc0 sc1 nt lds
    v_mfma_f32_16x16x16_bf16 v[188:191], v[226:227], v[76:77], v[188:191]
    v_mfma_f32_16x16x16_bf16 v[192:195], v[226:227], v[78:79], v[192:195]
    v_mfma_f32_16x16x16_bf16 v[196:199], v[226:227], v[80:81], v[196:199]
    v_mfma_f32_16x16x16_bf16 v[200:203], v[226:227], v[82:83], v[200:203]
    v_mfma_f32_16x16x16_bf16 v[204:207], v[226:227], v[84:85], v[204:207]
    v_mfma_f32_16x16x16_bf16 v[208:211], v[226:227], v[86:87], v[208:211]
    v_mfma_f32_16x16x16_bf16 v[212:215], v[226:227], v[88:89], v[212:215]
    v_mfma_f32_16x16x16_bf16 v[216:219], v[226:227], v[90:91], v[216:219]
    s_waitcnt vmcnt(4)
    s_add_u32 m0, s42, 24576
    s_add_u32 s43, s41, 360448
    buffer_load_dwordx4 v14, s[28:31], s43 offen offset:2048 sc0 sc1 nt lds
    buffer_load_dwordx4 v15, s[28:31], s43 offen offset:3072 sc0 sc1 nt lds
    v_fma_f32 v228, v132, s44, -v233
    v_fma_f32 v229, v133, s44, -v233
    v_fma_f32 v230, v134, s44, -v233
    v_fma_f32 v231, v135, s44, -v233
    v_exp_f32 v228, v228
    v_exp_f32 v229, v229
    v_exp_f32 v230, v230
    v_exp_f32 v231, v231
    s_nop 0
    v_cvt_pk_bf16_f32 v226, v228, v229
    v_cvt_pk_bf16_f32 v227, v230, v231
    s_waitcnt vmcnt(4)
    s_add_u32 m0, s42, 28672
    s_add_u32 s43, s41, 376832
    buffer_load_dwordx4 v12, s[28:31], s43 offen offset:0 sc0 sc1 nt lds
    buffer_load_dwordx4 v13, s[28:31], s43 offen offset:1024 sc0 sc1 nt lds
    ds_read_b64_tr_b16 v[60:61], v20 offset:16384
    ds_read_b64_tr_b16 v[62:63], v21 offset:16384
    ds_read_b64_tr_b16 v[64:65], v22 offset:16384
    ds_read_b64_tr_b16 v[66:67], v23 offset:16384
    ds_read_b64_tr_b16 v[68:69], v24 offset:16384
    ds_read_b64_tr_b16 v[70:71], v25 offset:16384
    ds_read_b64_tr_b16 v[72:73], v26 offset:16384
    ds_read_b64_tr_b16 v[74:75], v27 offset:16384
    ds_read_b64_tr_b16 v[76:77], v20 offset:16640
    ds_read_b64_tr_b16 v[78:79], v21 offset:16640
    ds_read_b64_tr_b16 v[80:81], v22 offset:16640
    ds_read_b64_tr_b16 v[82:83], v23 offset:16640
    ds_read_b64_tr_b16 v[84:85], v24 offset:16640
    ds_read_b64_tr_b16 v[86:87], v25 offset:16640
    ds_read_b64_tr_b16 v[88:89], v26 offset:16640
    ds_read_b64_tr_b16 v[90:91], v27 offset:16640
    s_waitcnt lgkmcnt(0)
    s_waitcnt vmcnt(4)
    s_add_u32 m0, s42, 28672
    s_add_u32 s43, s41, 376832
    buffer_load_dwordx4 v14, s[28:31], s43 offen offset:2048 sc0 sc1 nt lds
    buffer_load_dwordx4 v15, s[28:31], s43 offen offset:3072 sc0 sc1 nt lds
    s_cmp_lg_u32 s3, 0
    s_cbranch_scc1 L_noflag
    v_mov_b32 v243, 155200
    v_mov_b32 v244, 1
    ds_write_b32 v243, v244
L_noflag:
    v_mfma_f32_16x16x16_bf16 v[220:223], v[226:227], v[224:225], v[220:223]
    v_mfma_f32_16x16x16_bf16 v[156:159], v[226:227], v[60:61], v[156:159]
    v_mfma_f32_16x16x16_bf16 v[160:163], v[226:227], v[62:63], v[160:163]
    v_mfma_f32_16x16x16_bf16 v[164:167], v[226:227], v[64:65], v[164:167]
    v_mfma_f32_16x16x16_bf16 v[168:171], v[226:227], v[66:67], v[168:171]
    v_mfma_f32_16x16x16_bf16 v[172:175], v[226:227], v[68:69], v[172:175]
    v_mfma_f32_16x16x16_bf16 v[176:179], v[226:227], v[70:71], v[176:179]
    v_mfma_f32_16x16x16_bf16 v[180:183], v[226:227], v[72:73], v[180:183]
    v_mfma_f32_16x16x16_bf16 v[184:187], v[226:227], v[74:75], v[184:187]
    s_waitcnt vmcnt(4)
    s_add_u32 m0, s42, 0
    s_add_u32 s43, s41, 393216
    buffer_load_dwordx4 v12, s[28:31], s43 offen offset:0 sc0 sc1 nt lds
    buffer_load_dwordx4 v13, s[28:31], s43 offen offset:1024 sc0 sc1 nt lds
    v_mfma_f32_16x16x16_bf16 v[188:191], v[226:227], v[76:77], v[188:191]
    v_mfma_f32_16x16x16_bf16 v[192:195], v[226:227], v[78:79], v[192:195]
    v_mfma_f32_16x16x16_bf16 v[196:199], v[226:227], v[80:81], v[196:199]
    v_mfma_f32_16x16x16_bf16 v[200:203], v[226:227], v[82:83], v[200:203]
    v_mfma_f32_16x16x16_bf16 v[204:207], v[226:227], v[84:85], v[204:207]
    v_mfma_f32_16x16x16_bf16 v[208:211], v[226:227], v[86:87], v[208:211]
    v_mfma_f32_16x16x16_bf16 v[212:215], v[226:227], v[88:89], v[212:215]
    v_mfma_f32_16x16x16_bf16 v[216:219], v[226:227], v[90:91], v[216:219]
    s_waitcnt vmcnt(4)
    s_add_u32 m0, s42, 0
    s_add_u32 s43, s41, 393216
    buffer_load_dwordx4 v14, s[28:31], s43 offen offset:2048 sc0 sc1 nt lds
    buffer_load_dwordx4 v15, s[28:31], s43 offen offset:3072 sc0 sc1 nt lds
    v_fma_f32 v228, v136, s44, -v233
    v_fma_f32 v229, v137, s44, -v233
    v_fma_f32 v230, v138, s44, -v233
    v_fma_f32 v231, v139, s44, -v233
    v_exp_f32 v228, v228
    v_exp_f32 v229, v229
    v_exp_f32 v230, v230
    v_exp_f32 v231, v231
    s_nop 0
    v_cvt_pk_bf16_f32 v226, v228, v229
    v_cvt_pk_bf16_f32 v227, v230, v231
    s_waitcnt vmcnt(4)
    s_add_u32 m0, s42, 4096
    s_add_u32 s43, s41, 409600
    buffer_load_dwordx4 v12, s[28:31], s43 offen offset:0 sc0 sc1 nt lds
    buffer_load_dwordx4 v13, s[28:31], s43 offen offset:1024 sc0 sc1 nt lds
    ds_read_b64_tr_b16 v[60:61], v20 offset:24576
    ds_read_b64_tr_b16 v[62:63], v21 offset:24576
    ds_read_b64_tr_b16 v[64:65], v22 offset:24576
    ds_read_b64_tr_b16 v[66:67], v23 offset:24576
    ds_read_b64_tr_b16 v[68:69], v24 offset:24576
    ds_read_b64_tr_b16 v[70:71], v25 offset:24576
    ds_read_b64_tr_b16 v[72:73], v26 offset:24576
    ds_read_b64_tr_b16 v[74:75], v27 offset:24576
    ds_read_b64_tr_b16 v[76:77], v20 offset:24832
    ds_read_b64_tr_b16 v[78:79], v21 offset:24832
    ds_read_b64_tr_b16 v[80:81], v22 offset:24832
    ds_read_b64_tr_b16 v[82:83], v23 offset:24832
    ds_read_b64_tr_b16 v[84:85], v24 offset:24832
    ds_read_b64_tr_b16 v[86:87], v25 offset:24832
    ds_read_b64_tr_b16 v[88:89], v26 offset:24832
    ds_read_b64_tr_b16 v[90:91], v27 offset:24832
    s_waitcnt lgkmcnt(0)
    s_waitcnt vmcnt(4)
    s_add_u32 m0, s42, 4096
    s_add_u32 s43, s41, 409600
    buffer_load_dwordx4 v14, s[28:31], s43 offen offset:2048 sc0 sc1 nt lds
    buffer_load_dwordx4 v15, s[28:31], s43 offen offset:3072 sc0 sc1 nt lds
    v_mfma_f32_16x16x16_bf16 v[220:223], v[226:227], v[224:225], v[220:223]
    v_mfma_f32_16x16x16_bf16 v[156:159], v[226:227], v[60:61], v[156:159]
    v_mfma_f32_16x16x16_bf16 v[160:163], v[226:227], v[62:63], v[160:163]
    v_mfma_f32_16x16x16_bf16 v[164:167], v[226:227], v[64:65], v[164:167]
    v_mfma_f32_16x16x16_bf16 v[168:171], v[226:227], v[66:67], v[168:171]
    v_mfma_f32_16x16x16_bf16 v[172:175], v[226:227], v[68:69], v[172:175]
    v_mfma_f32_16x16x16_bf16 v[176:179], v[226:227], v[70:71], v[176:179]
    v_mfma_f32_16x16x16_bf16 v[180:183], v[226:227], v[72:73], v[180:183]
    v_mfma_f32_16x16x16_bf16 v[184:187], v[226:227], v[74:75], v[184:187]
    s_waitcnt vmcnt(4)
    s_add_u32 m0, s42, 8192
    s_add_u32 s43, s41, 425984
    buffer_load_dwordx4 v12, s[28:31], s43 offen offset:0 sc0 sc1 nt lds
    buffer_load_dwordx4 v13, s[28:31], s43 offen offset:1024 sc0 sc1 nt lds
    v_mfma_f32_16x16x16_bf16 v[188:191], v[226:227], v[76:77], v[188:191]
    v_mfma_f32_16x16x16_bf16 v[192:195], v[226:227], v[78:79], v[192:195]
    v_mfma_f32_16x16x16_bf16 v[196:199], v[226:227], v[80:81], v[196:199]
    v_mfma_f32_16x16x16_bf16 v[200:203], v[226:227], v[82:83], v[200:203]
    v_mfma_f32_16x16x16_bf16 v[204:207], v[226:227], v[84:85], v[204:207]
    v_mfma_f32_16x16x16_bf16 v[208:211], v[226:227], v[86:87], v[208:211]
    v_mfma_f32_16x16x16_bf16 v[212:215], v[226:227], v[88:89], v[212:215]
    v_mfma_f32_16x16x16_bf16 v[216:219], v[226:227], v[90:91], v[216:219]
    s_waitcnt vmcnt(4)
    s_add_u32 m0, s42, 8192
    s_add_u32 s43, s41, 425984
    buffer_load_dwordx4 v14, s[28:31], s43 offen offset:2048 sc0 sc1 nt lds
    buffer_load_dwordx4 v15, s[28:31], s43 offen offset:3072 sc0 sc1 nt lds
    v_fma_f32 v228, v140, s44, -v233
    v_fma_f32 v229, v141, s44, -v233
    v_fma_f32 v230, v142, s44, -v233
    v_fma_f32 v231, v143, s44, -v233
    v_exp_f32 v228, v228
    v_exp_f32 v229, v229
    v_exp_f32 v230, v230
    v_exp_f32 v231, v231
    s_nop 0
    v_cvt_pk_bf16_f32 v226, v228, v229
    v_cvt_pk_bf16_f32 v227, v230, v231
    s_waitcnt vmcnt(4)
    s_add_u32 m0, s42, 12288
    s_add_u32 s43, s41, 442368
    buffer_load_dwordx4 v12, s[28:31], s43 offen offset:0 sc0 sc1 nt lds
    buffer_load_dwordx4 v13, s[28:31], s43 offen offset:1024 sc0 sc1 nt lds
    ds_read_b64_tr_b16 v[60:61], v20 offset:0
    ds_read_b64_tr_b16 v[62:63], v21 offset:0
    ds_read_b64_tr_b16 v[64:65], v22 offset:0
    ds_read_b64_tr_b16 v[66:67], v23 offset:0
    ds_read_b64_tr_b16 v[68:69], v24 offset:0
    ds_read_b64_tr_b16 v[70:71], v25 offset:0
    ds_read_b64_tr_b16 v[72:73], v26 offset:0
    ds_read_b64_tr_b16 v[74:75], v27 offset:0
    ds_read_b64_tr_b16 v[76:77], v20 offset:256
    ds_read_b64_tr_b16 v[78:79], v21 offset:256
    ds_read_b64_tr_b16 v[80:81], v22 offset:256
    ds_read_b64_tr_b16 v[82:83], v23 offset:256
    ds_read_b64_tr_b16 v[84:85], v24 offset:256
    ds_read_b64_tr_b16 v[86:87], v25 offset:256
    ds_read_b64_tr_b16 v[88:89], v26 offset:256
    ds_read_b64_tr_b16 v[90:91], v27 offset:256
    s_waitcnt lgkmcnt(0)
    s_waitcnt vmcnt(4)
    s_add_u32 m0, s42, 12288
    s_add_u32 s43, s41, 442368
    buffer_load_dwordx4 v14, s[28:31], s43 offen offset:2048 sc0 sc1 nt lds
    buffer_load_dwordx4 v15, s[28:31], s43 offen offset:3072 sc0 sc1 nt lds
    v_mfma_f32_16x16x16_bf16 v[220:223], v[226:227], v[224:225], v[220:223]
    v_mfma_f32_16x16x16_bf16 v[156:159], v[226:227], v[60:61], v[156:159]
    v_mfma_f32_16x16x16_bf16 v[160:163], v[226:227], v[62:63], v[160:163]
    v_mfma_f32_16x16x16_bf16 v[164:167], v[226:227], v[64:65], v[164:167]
    v_mfma_f32_16x16x16_bf16 v[168:171], v[226:227], v[66:67], v[168:171]
    v_mfma_f32_16x16x16_bf16 v[172:175], v[226:227], v[68:69], v[172:175]
    v_mfma_f32_16x16x16_bf16 v[176:179], v[226:227], v[70:71], v[176:179]
    v_mfma_f32_16x16x16_bf16 v[180:183], v[226:227], v[72:73], v[180:183]
    v_mfma_f32_16x16x16_bf16 v[184:187], v[226:227], v[74:75], v[184:187]
    s_waitcnt vmcnt(4)
    s_add_u32 m0, s42, 16384
    s_add_u32 s43, s41, 458752
    buffer_load_dwordx4 v12, s[28:31], s43 offen offset:0 sc0 sc1 nt lds
    buffer_load_dwordx4 v13, s[28:31], s43 offen offset:1024 sc0 sc1 nt lds
    v_mfma_f32_16x16x16_bf16 v[188:191], v[226:227], v[76:77], v[188:191]
    v_mfma_f32_16x16x16_bf16 v[192:195], v[226:227], v[78:79], v[192:195]
    v_mfma_f32_16x16x16_bf16 v[196:199], v[226:227], v[80:81], v[196:199]
    v_mfma_f32_16x16x16_bf16 v[200:203], v[226:227], v[82:83], v[200:203]
    v_mfma_f32_16x16x16_bf16 v[204:207], v[226:227], v[84:85], v[204:207]
    v_mfma_f32_16x16x16_bf16 v[208:211], v[226:227], v[86:87], v[208:211]
    v_mfma_f32_16x16x16_bf16 v[212:215], v[226:227], v[88:89], v[212:215]
    v_mfma_f32_16x16x16_bf16 v[216:219], v[226:227], v[90:91], v[216:219]
    s_waitcnt vmcnt(4)
    s_add_u32 m0, s42, 16384
    s_add_u32 s43, s41, 458752
    buffer_load_dwordx4 v14, s[28:31], s43 offen offset:2048 sc0 sc1 nt lds
    buffer_load_dwordx4 v15, s[28:31], s43 offen offset:3072 sc0 sc1 nt lds
    v_fma_f32 v228, v144, s44, -v233
    v_fma_f32 v229, v145, s44, -v233
    v_fma_f32 v230, v146, s44, -v233
    v_fma_f32 v231, v147, s44, -v233
    v_exp_f32 v228, v228
    v_exp_f32 v229, v229
    v_exp_f32 v230, v230
    v_exp_f32 v231, v231
    s_nop 0
    v_cvt_pk_bf16_f32 v226, v228, v229
    v_cvt_pk_bf16_f32 v227, v230, v231
    s_waitcnt vmcnt(4)
    s_add_u32 m0, s42, 20480
    s_add_u32 s43, s41, 475136
    buffer_load_dwordx4 v12, s[28:31], s43 offen offset:0 sc0 sc1 nt lds
    buffer_load_dwordx4 v13, s[28:31], s43 offen offset:1024 sc0 sc1 nt lds
    ds_read_b64_tr_b16 v[60:61], v20 offset:8192
    ds_read_b64_tr_b16 v[62:63], v21 offset:8192
    ds_read_b64_tr_b16 v[64:65], v22 offset:8192
    ds_read_b64_tr_b16 v[66:67], v23 offset:8192
    ds_read_b64_tr_b16 v[68:69], v24 offset:8192
    ds_read_b64_tr_b16 v[70:71], v25 offset:8192
    ds_read_b64_tr_b16 v[72:73], v26 offset:8192
    ds_read_b64_tr_b16 v[74:75], v27 offset:8192
    ds_read_b64_tr_b16 v[76:77], v20 offset:8448
    ds_read_b64_tr_b16 v[78:79], v21 offset:8448
    ds_read_b64_tr_b16 v[80:81], v22 offset:8448
    ds_read_b64_tr_b16 v[82:83], v23 offset:8448
    ds_read_b64_tr_b16 v[84:85], v24 offset:8448
    ds_read_b64_tr_b16 v[86:87], v25 offset:8448
    ds_read_b64_tr_b16 v[88:89], v26 offset:8448
    ds_read_b64_tr_b16 v[90:91], v27 offset:8448
    s_waitcnt lgkmcnt(0)
    s_waitcnt vmcnt(4)
    s_add_u32 m0, s42, 20480
    s_add_u32 s43, s41, 475136
    buffer_load_dwordx4 v14, s[28:31], s43 offen offset:2048 sc0 sc1 nt lds
    buffer_load_dwordx4 v15, s[28:31], s43 offen offset:3072 sc0 sc1 nt lds
    v_mfma_f32_16x16x16_bf16 v[220:223], v[226:227], v[224:225], v[220:223]
    v_mfma_f32_16x16x16_bf16 v[156:159], v[226:227], v[60:61], v[156:159]
    v_mfma_f32_16x16x16_bf16 v[160:163], v[226:227], v[62:63], v[160:163]
    v_mfma_f32_16x16x16_bf16 v[164:167], v[226:227], v[64:65], v[164:167]
    v_mfma_f32_16x16x16_bf16 v[168:171], v[226:227], v[66:67], v[168:171]
    v_mfma_f32_16x16x16_bf16 v[172:175], v[226:227], v[68:69], v[172:175]
    v_mfma_f32_16x16x16_bf16 v[176:179], v[226:227], v[70:71], v[176:179]
    v_mfma_f32_16x16x16_bf16 v[180:183], v[226:227], v[72:73], v[180:183]
    v_mfma_f32_16x16x16_bf16 v[184:187], v[226:227], v[74:75], v[184:187]
    s_waitcnt vmcnt(4)
    s_add_u32 m0, s42, 24576
    s_add_u32 s43, s41, 491520
    buffer_load_dwordx4 v12, s[28:31], s43 offen offset:0 sc0 sc1 nt lds
    buffer_load_dwordx4 v13, s[28:31], s43 offen offset:1024 sc0 sc1 nt lds
    v_mfma_f32_16x16x16_bf16 v[188:191], v[226:227], v[76:77], v[188:191]
    v_mfma_f32_16x16x16_bf16 v[192:195], v[226:227], v[78:79], v[192:195]
    v_mfma_f32_16x16x16_bf16 v[196:199], v[226:227], v[80:81], v[196:199]
    v_mfma_f32_16x16x16_bf16 v[200:203], v[226:227], v[82:83], v[200:203]
    v_mfma_f32_16x16x16_bf16 v[204:207], v[226:227], v[84:85], v[204:207]
    v_mfma_f32_16x16x16_bf16 v[208:211], v[226:227], v[86:87], v[208:211]
    v_mfma_f32_16x16x16_bf16 v[212:215], v[226:227], v[88:89], v[212:215]
    v_mfma_f32_16x16x16_bf16 v[216:219], v[226:227], v[90:91], v[216:219]
    s_waitcnt vmcnt(4)
    s_add_u32 m0, s42, 24576
    s_add_u32 s43, s41, 491520
    buffer_load_dwordx4 v14, s[28:31], s43 offen offset:2048 sc0 sc1 nt lds
    buffer_load_dwordx4 v15, s[28:31], s43 offen offset:3072 sc0 sc1 nt lds
    v_fma_f32 v228, v148, s44, -v233
    v_fma_f32 v229, v149, s44, -v233
    v_fma_f32 v230, v150, s44, -v233
    v_fma_f32 v231, v151, s44, -v233
    v_exp_f32 v228, v228
    v_exp_f32 v229, v229
    v_exp_f32 v230, v230
    v_exp_f32 v231, v231
    s_nop 0
    v_cvt_pk_bf16_f32 v226, v228, v229
    v_cvt_pk_bf16_f32 v227, v230, v231
    s_waitcnt vmcnt(4)
    s_add_u32 m0, s42, 28672
    s_add_u32 s43, s41, 507904
    buffer_load_dwordx4 v12, s[28:31], s43 offen offset:0 sc0 sc1 nt lds
    buffer_load_dwordx4 v13, s[28:31], s43 offen offset:1024 sc0 sc1 nt lds
    ds_read_b64_tr_b16 v[60:61], v20 offset:16384
    ds_read_b64_tr_b16 v[62:63], v21 offset:16384
    ds_read_b64_tr_b16 v[64:65], v22 offset:16384
    ds_read_b64_tr_b16 v[66:67], v23 offset:16384
    ds_read_b64_tr_b16 v[68:69], v24 offset:16384
    ds_read_b64_tr_b16 v[70:71], v25 offset:16384
    ds_read_b64_tr_b16 v[72:73], v26 offset:16384
    ds_read_b64_tr_b16 v[74:75], v27 offset:16384
    ds_read_b64_tr_b16 v[76:77], v20 offset:16640
    ds_read_b64_tr_b16 v[78:79], v21 offset:16640
    ds_read_b64_tr_b16 v[80:81], v22 offset:16640
    ds_read_b64_tr_b16 v[82:83], v23 offset:16640
    ds_read_b64_tr_b16 v[84:85], v24 offset:16640
    ds_read_b64_tr_b16 v[86:87], v25 offset:16640
    ds_read_b64_tr_b16 v[88:89], v26 offset:16640
    ds_read_b64_tr_b16 v[90:91], v27 offset:16640
    s_waitcnt lgkmcnt(0)
    s_waitcnt vmcnt(4)
    s_add_u32 m0, s42, 28672
    s_add_u32 s43, s41, 507904
    buffer_load_dwordx4 v14, s[28:31], s43 offen offset:2048 sc0 sc1 nt lds
    buffer_load_dwordx4 v15, s[28:31], s43 offen offset:3072 sc0 sc1 nt lds
    v_mfma_f32_16x16x16_bf16 v[220:223], v[226:227], v[224:225], v[220:223]
    v_mfma_f32_16x16x16_bf16 v[156:159], v[226:227], v[60:61], v[156:159]
    v_mfma_f32_16x16x16_bf16 v[160:163], v[226:227], v[62:63], v[160:163]
    v_mfma_f32_16x16x16_bf16 v[164:167], v[226:227], v[64:65], v[164:167]
    v_mfma_f32_16x16x16_bf16 v[168:171], v[226:227], v[66:67], v[168:171]
    v_mfma_f32_16x16x16_bf16 v[172:175], v[226:227], v[68:69], v[172:175]
    v_mfma_f32_16x16x16_bf16 v[176:179], v[226:227], v[70:71], v[176:179]
    v_mfma_f32_16x16x16_bf16 v[180:183], v[226:227], v[72:73], v[180:183]
    v_mfma_f32_16x16x16_bf16 v[184:187], v[226:227], v[74:75], v[184:187]
    s_waitcnt vmcnt(4)
    v_mfma_f32_16x16x16_bf16 v[188:191], v[226:227], v[76:77], v[188:191]
    v_mfma_f32_16x16x16_bf16 v[192:195], v[226:227], v[78:79], v[192:195]
    v_mfma_f32_16x16x16_bf16 v[196:199], v[226:227], v[80:81], v[196:199]
    v_mfma_f32_16x16x16_bf16 v[200:203], v[226:227], v[82:83], v[200:203]
    v_mfma_f32_16x16x16_bf16 v[204:207], v[226:227], v[84:85], v[204:207]
    v_mfma_f32_16x16x16_bf16 v[208:211], v[226:227], v[86:87], v[208:211]
    v_mfma_f32_16x16x16_bf16 v[212:215], v[226:227], v[88:89], v[212:215]
    v_mfma_f32_16x16x16_bf16 v[216:219], v[226:227], v[90:91], v[216:219]
    s_waitcnt vmcnt(2)
    v_fma_f32 v228, v152, s44, -v233
    v_fma_f32 v229, v153, s44, -v233
    v_fma_f32 v230, v154, s44, -v233
    v_fma_f32 v231, v155, s44, -v233
    v_exp_f32 v228, v228
    v_exp_f32 v229, v229
    v_exp_f32 v230, v230
    v_exp_f32 v231, v231
    s_nop 0
    v_cvt_pk_bf16_f32 v226, v228, v229
    v_cvt_pk_bf16_f32 v227, v230, v231
    s_waitcnt vmcnt(0)
    ds_read_b64_tr_b16 v[60:61], v20 offset:24576
    ds_read_b64_tr_b16 v[62:63], v21 offset:24576
    ds_read_b64_tr_b16 v[64:65], v22 offset:24576
    ds_read_b64_tr_b16 v[66:67], v23 offset:24576
    ds_read_b64_tr_b16 v[68:69], v24 offset:24576
    ds_read_b64_tr_b16 v[70:71], v25 offset:24576
    ds_read_b64_tr_b16 v[72:73], v26 offset:24576
    ds_read_b64_tr_b16 v[74:75], v27 offset:24576
    ds_read_b64_tr_b16 v[76:77], v20 offset:24832
    ds_read_b64_tr_b16 v[78:79], v21 offset:24832
    ds_read_b64_tr_b16 v[80:81], v22 offset:24832
    ds_read_b64_tr_b16 v[82:83], v23 offset:24832
    ds_read_b64_tr_b16 v[84:85], v24 offset:24832
    ds_read_b64_tr_b16 v[86:87], v25 offset:24832
    ds_read_b64_tr_b16 v[88:89], v26 offset:24832
    ds_read_b64_tr_b16 v[90:91], v27 offset:24832
    v_mfma_f32_16x16x16_bf16 v[220:223], v[226:227], v[224:225], v[220:223]
    s_waitcnt lgkmcnt(15)
    v_mfma_f32_16x16x16_bf16 v[156:159], v[226:227], v[60:61], v[156:159]
    s_waitcnt lgkmcnt(14)
    v_mfma_f32_16x16x16_bf16 v[160:163], v[226:227], v[62:63], v[160:163]
    s_waitcnt lgkmcnt(13)
    v_mfma_f32_16x16x16_bf16 v[164:167], v[226:227], v[64:65], v[164:167]
    s_waitcnt lgkmcnt(12)
    v_mfma_f32_16x16x16_bf16 v[168:171], v[226:227], v[66:67], v[168:171]
    s_waitcnt lgkmcnt(11)
    v_mfma_f32_16x16x16_bf16 v[172:175], v[226:227], v[68:69], v[172:175]
    s_waitcnt lgkmcnt(10)
    v_mfma_f32_16x16x16_bf16 v[176:179], v[226:227], v[70:71], v[176:179]
    s_waitcnt lgkmcnt(9)
    v_mfma_f32_16x16x16_bf16 v[180:183], v[226:227], v[72:73], v[180:183]
    s_waitcnt lgkmcnt(8)
    v_mfma_f32_16x16x16_bf16 v[184:187], v[226:227], v[74:75], v[184:187]
    s_waitcnt lgkmcnt(7)
    v_mfma_f32_16x16x16_bf16 v[188:191], v[226:227], v[76:77], v[188:191]
    s_waitcnt lgkmcnt(6)
    v_mfma_f32_16x16x16_bf16 v[192:195], v[226:227], v[78:79], v[192:195]
    s_waitcnt lgkmcnt(5)
    v_mfma_f32_16x16x16_bf16 v[196:199], v[226:227], v[80:81], v[196:199]
    s_waitcnt lgkmcnt(4)
    v_mfma_f32_16x16x16_bf16 v[200:203], v[226:227], v[82:83], v[200:203]
    s_waitcnt lgkmcnt(3)
    v_mfma_f32_16x16x16_bf16 v[204:207], v[226:227], v[84:85], v[204:207]
    s_waitcnt lgkmcnt(2)
    v_mfma_f32_16x16x16_bf16 v[208:211], v[226:227], v[86:87], v[208:211]
    s_waitcnt lgkmcnt(1)
    v_mfma_f32_16x16x16_bf16 v[212:215], v[226:227], v[88:89], v[212:215]
    s_waitcnt lgkmcnt(0)
    v_mfma_f32_16x16x16_bf16 v[216:219], v[226:227], v[90:91], v[216:219]
    v_cmp_eq_u32 vcc, 1, v2
    s_nop 1
    v_cndmask_b32 v229, v220, v221, vcc
    v_mov_b32 v228, v233
    s_mov_b64 exec, 3
    ds_write_b64 v242, v[228:229]
    s_mov_b64 exec, 0xffff
    ds_write_b64 v241, v[156:157] offset:0
    ds_write_b64 v241, v[160:161] offset:128
    ds_write_b64 v241, v[164:165] offset:256
    ds_write_b64 v241, v[168:169] offset:384
    ds_write_b64 v241, v[172:173] offset:512
    ds_write_b64 v241, v[176:177] offset:640
    ds_write_b64 v241, v[180:181] offset:768
    ds_write_b64 v241, v[184:185] offset:896
    ds_write_b64 v241, v[188:189] offset:1024
    ds_write_b64 v241, v[192:193] offset:1152
    ds_write_b64 v241, v[196:197] offset:1280
    ds_write_b64 v241, v[200:201] offset:1408
    ds_write_b64 v241, v[204:205] offset:1536
    s_nop 1
    ds_write_b64 v241, v[208:209] offset:1664
    ds_write_b64 v241, v[212:213] offset:1792
    ds_write_b64 v241, v[216:217] offset:1920
    s_mov_b64 exec, -1
    s_waitcnt lgkmcnt(0)
    s_barrier
    s_endpgm
L_help:
    s_lshl_b32 s40, s22, 3
    s_add_u32 s40, s40, s20
    s_lshl_b32 s41, s20, 2
    s_add_u32 s41, s41, s23
    s_cmp_eq_u32 s3, 0
    s_cbranch_scc0 L_not_w0
    v_and_b32 v4, 7, v2
    v_mul_u32_u24 v4, 896, v4
    v_lshl_add_u32 v4, v3, 3, v4
    s_mul_i32 s43, s23, 224
    v_add_u32 v4, s43, v4
    v_lshrrev_b32 v5, 3, v1
    v_lshlrev_b32 v5, 13, v5
    v_and_b32 v6, 7, v1
    v_lshlrev_b32 v8, 1, v3
    v_xor_b32 v6, v6, v8
    v_lshl_add_u32 v5, v6, 4, v5
    s_mul_i32 s42, s23, 112*8192
    s_lshl_b32 s43, s20, 10
    s_add_u32 s42, s42, s43
    s_lshl_b32 s43, s22, 7
    s_add_u32 s42, s42, s43
    v_mov_b32 v7, 3276800
    v_and_b32 v8, 1, v3
    v_lshlrev_b32 v8, 2, v8
    v_lshrrev_b32 v9, 1, v3
    v_lshl_add_u32 v8, v9, 1, v8
    s_lshl_b32 s48, s20, 3
    v_add_u32 v8, s48, v8
    v_lshlrev_b32 v8, 2, v8
    v_add_u32 v8, s23, v8
    v_lshlrev_b32 v8, 7, v8
    s_lshl_b32 s48, s22, 4
    v_add_u32 v8, s48, v8
    v_add_u32 v8, v8, v2
    v_lshlrev_b32 v36, 4, v8
    s_waitcnt lgkmcnt(0)
    s_mov_b32 s24, s10
    s_mov_b32 s25, s11
    s_mov_b32 s26, 3670016
    s_mov_b32 s27, 0x20000
    s_mov_b32 m0, 131072
    s_add_u32 s43, s42, 0
    buffer_load_dwordx4 v5, s[24:27], s43 offen nt lds
    s_mov_b32 m0, 132096
    s_add_u32 s43, s42, 65536
    buffer_load_dwordx4 v5, s[24:27], s43 offen nt lds
    s_mov_b32 m0, 133120
    s_add_u32 s43, s42, 131072
    buffer_load_dwordx4 v5, s[24:27], s43 offen nt lds
    s_mov_b32 m0, 134144
    s_add_u32 s43, s42, 196608
    buffer_load_dwordx4 v5, s[24:27], s43 offen nt lds
    s_mov_b32 m0, 135168
    s_add_u32 s43, s42, 262144
    buffer_load_dwordx4 v5, s[24:27], s43 offen nt lds
    s_mov_b32 m0, 136192
    s_add_u32 s43, s42, 327680
    buffer_load_dwordx4 v5, s[24:27], s43 offen nt lds
    s_mov_b32 m0, 137216
    s_add_u32 s43, s42, 393216
    buffer_load_dwordx4 v5, s[24:27], s43 offen nt lds
    s_mov_b32 m0, 138240
    s_add_u32 s43, s42, 458752
    buffer_load_dwordx4 v5, s[24:27], s43 offen nt lds
    s_mov_b32 m0, 139264
    s_add_u32 s43, s42, 524288
    buffer_load_dwordx4 v5, s[24:27], s43 offen nt lds
    s_mov_b32 m0, 140288
    s_add_u32 s43, s42, 589824
    buffer_load_dwordx4 v5, s[24:27], s43 offen nt lds
    s_mov_b32 m0, 141312
    s_add_u32 s43, s42, 655360
    buffer_load_dwordx4 v5, s[24:27], s43 offen nt lds
    s_mov_b32 m0, 142336
    s_add_u32 s43, s42, 720896
    buffer_load_dwordx4 v5, s[24:27], s43 offen nt lds
    s_mov_b32 m0, 143360
    s_add_u32 s43, s42, 786432
    buffer_load_dwordx4 v5, s[24:27], s43 offen nt lds
    s_mov_b32 m0, 144384
    s_add_u32 s43, s42, 851968
    buffer_load_dwordx4 v5, s[24:27], s43 offen nt lds
    global_load_dwordx2 v[16:17], v4, s[4:5] offset:0
    global_load_dwordx2 v[18:19], v4, s[4:5] offset:32
    global_load_dwordx2 v[20:21], v4, s[4:5] offset:64
    global_load_dwordx2 v[22:23], v4, s[4:5] offset:96
    global_load_dwordx2 v[24:25], v4, s[4:5] offset:128
    global_load_dwordx2 v[26:27], v4, s[4:5] offset:160
    global_load_dwordx2 v[28:29], v4, s[4:5] offset:192
    global_load_dwordx2 v[12:13], v7, s[18:19]
    s_barrier
    v_lshrrev_b32 v6, 2, v2
    v_lshl_add_u32 v6, v3, 2, v6
    v_lshlrev_b32 v8, 7, v6
    v_and_b32 v9, 1, v2
    v_lshl_add_u32 v8, v9, 3, v8
    v_add_u32 v8, 131072, v8
    v_bfe_u32 v6, v6, 1, 2
    v_lshlrev_b32 v6, 1, v6
    v_bfe_u32 v9, v2, 1, 1
    v_add_u32 v10, 0, v9
    v_xor_b32 v10, v10, v6
    v_lshl_add_u32 v32, v10, 4, v8
    v_add_u32 v10, 2, v9
    v_xor_b32 v10, v10, v6
    v_lshl_add_u32 v33, v10, 4, v8
    v_add_u32 v10, 4, v9
    v_xor_b32 v10, v10, v6
    v_lshl_add_u32 v34, v10, 4, v8
    v_add_u32 v10, 6, v9
    v_xor_b32 v10, v10, v6
    v_lshl_add_u32 v35, v10, 4, v8
    v_cmp_gt_u32 s[50:51], 2, v3
    s_waitcnt vmcnt(8)
    ds_read_b64_tr_b16 v[72:73], v32 offset:0
    ds_read_b64_tr_b16 v[74:75], v33 offset:0
    ds_read_b64_tr_b16 v[76:77], v34 offset:0
    ds_read_b64_tr_b16 v[78:79], v35 offset:0
    ds_read_b64_tr_b16 v[80:81], v32 offset:2048
    ds_read_b64_tr_b16 v[82:83], v33 offset:2048
    ds_read_b64_tr_b16 v[84:85], v34 offset:2048
    ds_read_b64_tr_b16 v[86:87], v35 offset:2048
    ds_read_b64_tr_b16 v[88:89], v32 offset:4096
    ds_read_b64_tr_b16 v[90:91], v33 offset:4096
    ds_read_b64_tr_b16 v[92:93], v34 offset:4096
    ds_read_b64_tr_b16 v[94:95], v35 offset:4096
    ds_read_b64_tr_b16 v[96:97], v32 offset:6144
    ds_read_b64_tr_b16 v[98:99], v33 offset:6144
    ds_read_b64_tr_b16 v[100:101], v34 offset:6144
    ds_read_b64_tr_b16 v[102:103], v35 offset:6144
    ds_read_b64_tr_b16 v[104:105], v32 offset:8192
    ds_read_b64_tr_b16 v[106:107], v33 offset:8192
    ds_read_b64_tr_b16 v[108:109], v34 offset:8192
    ds_read_b64_tr_b16 v[110:111], v35 offset:8192
    ds_read_b64_tr_b16 v[112:113], v32 offset:10240
    ds_read_b64_tr_b16 v[114:115], v33 offset:10240
    ds_read_b64_tr_b16 v[116:117], v34 offset:10240
    ds_read_b64_tr_b16 v[118:119], v35 offset:10240
    ds_read_b64_tr_b16 v[120:121], v32 offset:12288
    ds_read_b64_tr_b16 v[122:123], v33 offset:12288
    ds_read_b64_tr_b16 v[124:125], v34 offset:12288
    ds_read_b64_tr_b16 v[126:127], v35 offset:12288
    s_waitcnt vmcnt(0)
    v_readfirstlane_b32 s44, v12
    v_readfirstlane_b32 s45, v13
    s_nop 1
    s_add_u32 s44, s44, 0x9e3779b9
    s_add_u32 s45, s45, 0x7f4a7c15
    s_getreg_b32 s36, hwreg(HW_REG_XCC_ID, 0, 4)
    s_waitcnt lgkmcnt(0)
    v_mfma_f32_16x16x16_bf16 v[128:131], v[16:17], v[72:73], 0
    v_mfma_f32_16x16x16_bf16 v[132:135], v[16:17], v[74:75], 0
    v_mfma_f32_16x16x16_bf16 v[136:139], v[16:17], v[76:77], 0
    v_mfma_f32_16x16x16_bf16 v[140:143], v[16:17], v[78:79], 0
    v_mfma_f32_16x16x16_bf16 v[128:131], v[18:19], v[80:81], v[128:131]
    v_mfma_f32_16x16x16_bf16 v[132:135], v[18:19], v[82:83], v[132:135]
    v_mfma_f32_16x16x16_bf16 v[136:139], v[18:19], v[84:85], v[136:139]
    v_mfma_f32_16x16x16_bf16 v[140:143], v[18:19], v[86:87], v[140:143]
    v_mfma_f32_16x16x16_bf16 v[128:131], v[20:21], v[88:89], v[128:131]
    v_mfma_f32_16x16x16_bf16 v[132:135], v[20:21], v[90:91], v[132:135]
    v_mfma_f32_16x16x16_bf16 v[136:139], v[20:21], v[92:93], v[136:139]
    v_mfma_f32_16x16x16_bf16 v[140:143], v[20:21], v[94:95], v[140:143]
    v_mfma_f32_16x16x16_bf16 v[128:131], v[22:23], v[96:97], v[128:131]
    v_mfma_f32_16x16x16_bf16 v[132:135], v[22:23], v[98:99], v[132:135]
    v_mfma_f32_16x16x16_bf16 v[136:139], v[22:23], v[100:101], v[136:139]
    v_mfma_f32_16x16x16_bf16 v[140:143], v[22:23], v[102:103], v[140:143]
    v_mfma_f32_16x16x16_bf16 v[128:131], v[24:25], v[104:105], v[128:131]
    v_mfma_f32_16x16x16_bf16 v[132:135], v[24:25], v[106:107], v[132:135]
    v_mfma_f32_16x16x16_bf16 v[136:139], v[24:25], v[108:109], v[136:139]
    v_mfma_f32_16x16x16_bf16 v[140:143], v[24:25], v[110:111], v[140:143]
    v_mfma_f32_16x16x16_bf16 v[128:131], v[26:27], v[112:113], v[128:131]
    v_mfma_f32_16x16x16_bf16 v[132:135], v[26:27], v[114:115], v[132:135]
    v_mfma_f32_16x16x16_bf16 v[136:139], v[26:27], v[116:117], v[136:139]
    v_mfma_f32_16x16x16_bf16 v[140:143], v[26:27], v[118:119], v[140:143]
    v_mfma_f32_16x16x16_bf16 v[128:131], v[28:29], v[120:121], v[128:131]
    v_mfma_f32_16x16x16_bf16 v[132:135], v[28:29], v[122:123], v[132:135]
    v_mfma_f32_16x16x16_bf16 v[136:139], v[28:29], v[124:125], v[136:139]
    v_mfma_f32_16x16x16_bf16 v[140:143], v[28:29], v[126:127], v[140:143]
    s_and_b32 s28, s44, 0x3ff
    s_bfe_u32 s29, s44, 0xa000a
    s_bfe_u32 s30, s44, 0xa0014
    s_and_b32 s31, s45, 0x3f0
    s_or_b32 s31, s31, s36
    s_mov_b32 s32, 0xfffffc00
    s_nop 5
    v_cndmask_b32 v40, v130, v128, s[50:51]
    v_cndmask_b32 v41, v134, v132, s[50:51]
    v_cndmask_b32 v42, v138, v136, s[50:51]
    v_cndmask_b32 v43, v142, v140, s[50:51]
    v_cndmask_b32 v44, v131, v129, s[50:51]
    v_cndmask_b32 v45, v135, v133, s[50:51]
    v_cndmask_b32 v46, v139, v137, s[50:51]
    v_cndmask_b32 v47, v143, v141, s[50:51]
    v_add_u32 v40, 0x200, v40
    v_add_u32 v41, 0x200, v41
    v_add_u32 v42, 0x200, v42
    v_add_u32 v43, 0x200, v43
    v_add_u32 v44, 0x200, v44
    v_add_u32 v45, 0x200, v45
    v_add_u32 v46, 0x200, v46
    v_add_u32 v47, 0x200, v47
    v_mov_b32 v48, s28
    v_mov_b32 v49, s29
    v_mov_b32 v50, s30
    v_mov_b32 v51, s31
    v_and_or_b32 v40, v40, s32, v48
    v_and_or_b32 v41, v41, s32, v49
    v_and_or_b32 v42, v42, s32, v50
    v_and_or_b32 v43, v43, s32, v51
    v_and_or_b32 v44, v44, s32, v48
    v_and_or_b32 v45, v45, s32, v49
    v_and_or_b32 v46, v46, s32, v50
    v_and_or_b32 v47, v47, s32, v51
    global_store_dwordx4 v36, v[40:43], s[18:19] sc1
    v_add_u32 v36, 8192, v36
    global_store_dwordx4 v36, v[44:47], s[18:19] sc1
    s_lshl_b32 s48, s20, 3
    s_add_u32 s48, s48, s22
    s_lshl_b32 s48, s48, 13
    v_lshl_add_u32 v12, v1, 4, s48
    s_lshl_b32 s43, s23, 11
    s_xor_b32 s46, s43, 0
    v_add_u32 v8, s46, v12
    s_xor_b32 s46, s43, 2048
    v_add_u32 v9, s46, v12
    s_xor_b32 s46, s43, 4096
    v_add_u32 v10, s46, v12
    s_xor_b32 s46, s43, 6144
    v_add_u32 v11, s46, v12
    s_sleep 36
    global_load_dwordx4 v[64:67], v8, s[18:19] offset:0 sc1
    global_load_dwordx4 v[68:71], v8, s[18:19] offset:1024 sc1
    s_waitcnt vmcnt(0)
    s_sleep 24
    s_mov_b32 s47, 0
L_qpoll:
    global_load_dwordx4 v[64:67], v8, s[18:19] offset:0 sc1
    global_load_dwordx4 v[68:71], v8, s[18:19] offset:1024 sc1
    global_load_dwordx4 v[72:75], v9, s[18:19] offset:0 sc1
    global_load_dwordx4 v[76:79], v9, s[18:19] offset:1024 sc1
    global_load_dwordx4 v[80:83], v10, s[18:19] offset:0 sc1
    global_load_dwordx4 v[84:87], v10, s[18:19] offset:1024 sc1
    global_load_dwordx4 v[88:91], v11, s[18:19] offset:0 sc1
    global_load_dwordx4 v[92:95], v11, s[18:19] offset:1024 sc1
    s_waitcnt vmcnt(0)
    v_xor_b32 v32, s28, v64
    v_xor_b32 v33, s29, v65
    v_xor_b32 v34, s30, v66
    v_or3_b32 v32, v32, v33, v34
    v_xor_b32 v35, s31, v67
    v_xor_b32 v33, s28, v68
    v_xor_b32 v34, s29, v69
    v_or3_b32 v32, v32, v33, v34
    v_xor_b32 v33, s30, v70
    v_xor_b32 v34, s31, v71
    v_or_b32 v32, v32, v33
    v_or_b32 v35, v35, v34
    v_xor_b32 v33, s28, v72
    v_xor_b32 v34, s29, v73
    v_or3_b32 v32, v32, v33, v34
    v_xor_b32 v33, s30, v74
    v_xor_b32 v34, s31, v75
    v_or_b32 v32, v32, v33
    v_or_b32 v35, v35, v34
    v_xor_b32 v33, s28, v76
    v_xor_b32 v34, s29, v77
    v_or3_b32 v32, v32, v33, v34
    v_xor_b32 v33, s30, v78
    v_xor_b32 v34, s31, v79
    v_or_b32 v32, v32, v33
    v_or_b32 v35, v35, v34
    v_xor_b32 v33, s28, v80
    v_xor_b32 v34, s29, v81
    v_or3_b32 v32, v32, v33, v34
    v_xor_b32 v33, s30, v82
    v_xor_b32 v34, s31, v83
    v_or_b32 v32, v32, v33
    v_or_b32 v35, v35, v34
    v_xor_b32 v33, s28, v84
    v_xor_b32 v34, s29, v85
    v_or3_b32 v32, v32, v33, v34
    v_xor_b32 v33, s30, v86
    v_xor_b32 v34, s31, v87
    v_or_b32 v32, v32, v33
    v_or_b32 v35, v35, v34
    v_xor_b32 v33, s28, v88
    v_xor_b32 v34, s29, v89
    v_or3_b32 v32, v32, v33, v34
    v_xor_b32 v33, s30, v90
    v_xor_b32 v34, s31, v91
    v_or_b32 v32, v32, v33
    v_or_b32 v35, v35, v34
    v_xor_b32 v33, s28, v92
    v_xor_b32 v34, s29, v93
    v_or3_b32 v32, v32, v33, v34
    v_xor_b32 v33, s30, v94
    v_xor_b32 v34, s31, v95
    v_or_b32 v32, v32, v33
    v_or_b32 v35, v35, v34
    v_and_b32 v32, 0x3ff, v32
    v_and_b32 v35, 0x3ff, v35
    v_and_b32 v33, 0x3f0, v35
    v_or_b32 v32, v32, v33
    v_cmp_ne_u32 vcc, 0, v32
    s_cbranch_vccz L_qdone
    s_sleep 8
    s_add_u32 s47, s47, 1
    s_cmp_le_u32 s47, 200000
    s_cbranch_scc1 L_qpoll
L_qdone:
    v_or_b32 v33, v32, v35
    v_cmp_ne_u32 vcc, 0, v33
    s_cmp_eq_u64 vcc, 0
    s_cselect_b32 s36, 1, 0
    v_mov_b32 v33, 155456
    v_mov_b32 v36, s36
    ds_write_b32 v33, v36
    v_mov_b32 v33, 155464
    v_mov_b32 v36, s44
    v_mov_b32 v37, s45
    ds_write_b64 v33, v[36:37]
    v_lshlrev_b32 v8, 7, v3
    v_lshl_add_u32 v8, v2, 1, v8
    v_add_u32 v8, 145408, v8
    v_and_b32 v64, s32, v64
    v_and_b32 v65, s32, v65
    v_and_b32 v66, s32, v66
    v_and_b32 v67, s32, v67
    v_and_b32 v68, s32, v68
    v_and_b32 v69, s32, v69
    v_and_b32 v70, s32, v70
    v_and_b32 v71, s32, v71
    v_and_b32 v72, s32, v72
    v_and_b32 v73, s32, v73
    v_and_b32 v74, s32, v74
    v_and_b32 v75, s32, v75
    v_and_b32 v76, s32, v76
    v_and_b32 v77, s32, v77
    v_and_b32 v78, s32, v78
    v_and_b32 v79, s32, v79
    v_and_b32 v80, s32, v80
    v_and_b32 v81, s32, v81
    v_and_b32 v82, s32, v82
    v_and_b32 v83, s32, v83
    v_and_b32 v84, s32, v84
    v_and_b32 v85, s32, v85
    v_and_b32 v86, s32, v86
    v_and_b32 v87, s32, v87
    v_and_b32 v88, s32, v88
    v_and_b32 v89, s32, v89
    v_and_b32 v90, s32, v90
    v_and_b32 v91, s32, v91
    v_and_b32 v92, s32, v92
    v_and_b32 v93, s32, v93
    v_and_b32 v94, s32, v94
    v_and_b32 v95, s32, v95
    v_add_f32 v32, v64, v72
    v_add_f32 v40, v80, v88
    v_add_f32 v33, v65, v73
    v_add_f32 v41, v81, v89
    v_add_f32 v34, v66, v74
    v_add_f32 v42, v82, v90
    v_add_f32 v35, v67, v75
    v_add_f32 v43, v83, v91
    v_add_f32 v36, v68, v76
    v_add_f32 v44, v84, v92
    v_add_f32 v37, v69, v77
    v_add_f32 v45, v85, v93
    v_add_f32 v38, v70, v78
    v_add_f32 v46, v86, v94
    v_add_f32 v39, v71, v79
    v_add_f32 v47, v87, v95
    v_add_f32 v32, v32, v40
    v_add_f32 v33, v33, v41
    v_add_f32 v34, v34, v42
    v_add_f32 v35, v35, v43
    v_add_f32 v36, v36, v44
    v_add_f32 v37, v37, v45
    v_add_f32 v38, v38, v46
    v_add_f32 v39, v39, v47
    v_cvt_pk_bf16_f32 v48, v32, v33
    v_cvt_pk_bf16_f32 v49, v34, v35
    v_cvt_pk_bf16_f32 v50, v36, v37
    v_cvt_pk_bf16_f32 v51, v38, v39
    ds_write_b16 v8, v48 offset:0
    ds_write_b16_d16_hi v8, v48 offset:32
    ds_write_b16 v8, v49 offset:64
    ds_write_b16_d16_hi v8, v49 offset:96
    ds_write_b16 v8, v50 offset:512
    ds_write_b16_d16_hi v8, v50 offset:544
    ds_write_b16 v8, v51 offset:576
    ds_write_b16_d16_hi v8, v51 offset:608
    s_waitcnt lgkmcnt(0)
    s_branch L_hb1
L_not_w0:
    s_waitcnt lgkmcnt(0)
    s_barrier
L_hb1:
    v_mov_b32 v16, 155200
    v_mov_b32 v17, 0
    ds_write_b32 v16, v17
    s_waitcnt lgkmcnt(0)
    s_barrier
    v_mov_b32 v16, 155456
    ds_read_b32 v17, v16
    v_mov_b32 v10, 155464
    ds_read_b64 v[12:13], v10
    s_waitcnt lgkmcnt(0)
    v_readfirstlane_b32 s37, v17
    v_readfirstlane_b32 s44, v12
    v_readfirstlane_b32 s45, v13
    s_mov_b32 s24, s12
    s_mov_b32 s25, s13
    s_mov_b32 s26, 3670016
    s_mov_b32 s27, 0x20000
    v_mul_u32_u24 v46, 7168, v3
    s_lshl_b32 s42, s3, 8
    v_lshl_add_u32 v46, v2, 4, v46
    v_add_u32 v46, s42, v46
    v_add_u32 v47, 3584, v46
    s_lshl_b32 s33, s41, 7
    s_mul_i32 s33, s33, 896
    s_mov_b32 s50, 0x05040100
    s_mov_b32 s51, 0x07060302
    s_mov_b32 s52, -1
    s_mov_b32 s53, -1
    s_cmp_eq_u32 s3, 3
    s_cselect_b32 s52, 0x00ff00ff, s52
    s_cselect_b32 s53, 0x00ff00ff, s53
    s_mul_i32 s46, s22, 896
    s_add_u32 s46, s46, s33
    s_mov_b64 exec, s[52:53]
    s_add_u32 s43, s46, 0
    buffer_load_dwordx4 v[96:99], v46, s[24:27], s43 offen
    s_add_u32 s43, s46, 28672
    buffer_load_dwordx4 v[100:103], v46, s[24:27], s43 offen
    s_add_u32 s43, s46, 57344
    buffer_load_dwordx4 v[104:107], v46, s[24:27], s43 offen
    s_add_u32 s43, s46, 86016
    buffer_load_dwordx4 v[108:111], v46, s[24:27], s43 offen
    s_mov_b64 exec, -1
    s_waitcnt vmcnt(0)
    s_sleep 32
    s_add_u32 s43, s33, 0
    s_mov_b64 exec, s[52:53]
    buffer_load_dwordx4 v[96:99], v46, s[24:27], s43 offen offset:0
    buffer_load_dwordx4 v[100:103], v46, s[24:27], s43 offen offset:896
    buffer_load_dwordx4 v[104:107], v46, s[24:27], s43 offen offset:1792
    buffer_load_dwordx4 v[108:111], v46, s[24:27], s43 offen offset:2688
    s_waitcnt vmcnt(0)
    buffer_load_dwordx4 v[112:115], v47, s[24:27], s43 offen offset:0
    buffer_load_dwordx4 v[116:119], v47, s[24:27], s43 offen offset:896
    buffer_load_dwordx4 v[120:123], v47, s[24:27], s43 offen offset:1792
    buffer_load_dwordx4 v[124:127], v47, s[24:27], s43 offen offset:2688
    s_waitcnt vmcnt(0)
    s_mov_b64 exec, -1
    v_perm_b32 v128, v100, v96, s50
    v_perm_b32 v129, v108, v104, s50
    v_perm_b32 v130, v116, v112, s50
    v_perm_b32 v131, v124, v120, s50
    v_perm_b32 v132, v100, v96, s51
    v_perm_b32 v133, v108, v104, s51
    v_perm_b32 v134, v116, v112, s51
    v_perm_b32 v135, v124, v120, s51
    v_perm_b32 v136, v101, v97, s50
    v_perm_b32 v137, v109, v105, s50
    v_perm_b32 v138, v117, v113, s50
    v_perm_b32 v139, v125, v121, s50
    v_perm_b32 v140, v101, v97, s51
    v_perm_b32 v141, v109, v105, s51
    v_perm_b32 v142, v117, v113, s51
    v_perm_b32 v143, v125, v121, s51
    v_perm_b32 v144, v102, v98, s50
    v_perm_b32 v145, v110, v106, s50
    v_perm_b32 v146, v118, v114, s50
    v_perm_b32 v147, v126, v122, s50
    v_perm_b32 v148, v102, v98, s51
    v_perm_b32 v149, v110, v106, s51
    v_perm_b32 v150, v118, v114, s51
    v_perm_b32 v151, v126, v122, s51
    v_perm_b32 v152, v103, v99, s50
    v_perm_b32 v153, v111, v107, s50
    v_perm_b32 v154, v119, v115, s50
    v_perm_b32 v155, v127, v123, s50
    v_perm_b32 v156, v103, v99, s51
    v_perm_b32 v157, v111, v107, s51
    v_perm_b32 v158, v119, v115, s51
    v_perm_b32 v159, v127, v123, s51
    s_add_u32 s43, s33, 28672
    s_mov_b64 exec, s[52:53]
    buffer_load_dwordx4 v[96:99], v46, s[24:27], s43 offen offset:0
    buffer_load_dwordx4 v[100:103], v46, s[24:27], s43 offen offset:896
    buffer_load_dwordx4 v[104:107], v46, s[24:27], s43 offen offset:1792
    buffer_load_dwordx4 v[108:111], v46, s[24:27], s43 offen offset:2688
    s_waitcnt vmcnt(0)
    buffer_load_dwordx4 v[112:115], v47, s[24:27], s43 offen offset:0
    buffer_load_dwordx4 v[116:119], v47, s[24:27], s43 offen offset:896
    buffer_load_dwordx4 v[120:123], v47, s[24:27], s43 offen offset:1792
    buffer_load_dwordx4 v[124:127], v47, s[24:27], s43 offen offset:2688
    s_waitcnt vmcnt(0)
    s_mov_b64 exec, -1
    v_perm_b32 v160, v100, v96, s50
    v_perm_b32 v161, v108, v104, s50
    v_perm_b32 v162, v116, v112, s50
    v_perm_b32 v163, v124, v120, s50
    v_perm_b32 v164, v100, v96, s51
    v_perm_b32 v165, v108, v104, s51
    v_perm_b32 v166, v116, v112, s51
    v_perm_b32 v167, v124, v120, s51
    v_perm_b32 v168, v101, v97, s50
    v_perm_b32 v169, v109, v105, s50
    v_perm_b32 v170, v117, v113, s50
    v_perm_b32 v171, v125, v121, s50
    v_perm_b32 v172, v101, v97, s51
    v_perm_b32 v173, v109, v105, s51
    v_perm_b32 v174, v117, v113, s51
    v_perm_b32 v175, v125, v121, s51
    v_perm_b32 v176, v102, v98, s50
    v_perm_b32 v177, v110, v106, s50
    v_perm_b32 v178, v118, v114, s50
    v_perm_b32 v179, v126, v122, s50
    v_perm_b32 v180, v102, v98, s51
    v_perm_b32 v181, v110, v106, s51
    v_perm_b32 v182, v118, v114, s51
    v_perm_b32 v183, v126, v122, s51
    v_perm_b32 v184, v103, v99, s50
    v_perm_b32 v185, v111, v107, s50
    v_perm_b32 v186, v119, v115, s50
    v_perm_b32 v187, v127, v123, s50
    v_perm_b32 v188, v103, v99, s51
    v_perm_b32 v189, v111, v107, s51
    v_perm_b32 v190, v119, v115, s51
    v_perm_b32 v191, v127, v123, s51
    s_add_u32 s43, s33, 57344
    s_mov_b64 exec, s[52:53]
    buffer_load_dwordx4 v[96:99], v46, s[24:27], s43 offen offset:0
    buffer_load_dwordx4 v[100:103], v46, s[24:27], s43 offen offset:896
    buffer_load_dwordx4 v[104:107], v46, s[24:27], s43 offen offset:1792
    buffer_load_dwordx4 v[108:111], v46, s[24:27], s43 offen offset:2688
    s_waitcnt vmcnt(0)
    buffer_load_dwordx4 v[112:115], v47, s[24:27], s43 offen offset:0
    buffer_load_dwordx4 v[116:119], v47, s[24:27], s43 offen offset:896
    buffer_load_dwordx4 v[120:123], v47, s[24:27], s43 offen offset:1792
    buffer_load_dwordx4 v[124:127], v47, s[24:27], s43 offen offset:2688
    s_waitcnt vmcnt(0)
    s_mov_b64 exec, -1
    v_perm_b32 v192, v100, v96, s50
    v_perm_b32 v193, v108, v104, s50
    v_perm_b32 v194, v116, v112, s50
    v_perm_b32 v195, v124, v120, s50
    v_perm_b32 v196, v100, v96, s51
    v_perm_b32 v197, v108, v104, s51
    v_perm_b32 v198, v116, v112, s51
    v_perm_b32 v199, v124, v120, s51
    v_perm_b32 v200, v101, v97, s50
    v_perm_b32 v201, v109, v105, s50
    v_perm_b32 v202, v117, v113, s50
    v_perm_b32 v203, v125, v121, s50
    v_perm_b32 v204, v101, v97, s51
    v_perm_b32 v205, v109, v105, s51
    v_perm_b32 v206, v117, v113, s51
    v_perm_b32 v207, v125, v121, s51
    v_perm_b32 v208, v102, v98, s50
    v_perm_b32 v209, v110, v106, s50
    v_perm_b32 v210, v118, v114, s50
    v_perm_b32 v211, v126, v122, s50
    v_perm_b32 v212, v102, v98, s51
    v_perm_b32 v213, v110, v106, s51
    v_perm_b32 v214, v118, v114, s51
    v_perm_b32 v215, v126, v122, s51
    v_perm_b32 v216, v103, v99, s50
    v_perm_b32 v217, v111, v107, s50
    v_perm_b32 v218, v119, v115, s50
    v_perm_b32 v219, v127, v123, s50
    v_perm_b32 v220, v103, v99, s51
    v_perm_b32 v221, v111, v107, s51
    v_perm_b32 v222, v119, v115, s51
    v_perm_b32 v223, v127, v123, s51
    s_add_u32 s43, s33, 86016
    s_mov_b64 exec, s[52:53]
    buffer_load_dwordx4 v[96:99], v46, s[24:27], s43 offen offset:0
    buffer_load_dwordx4 v[100:103], v46, s[24:27], s43 offen offset:896
    buffer_load_dwordx4 v[104:107], v46, s[24:27], s43 offen offset:1792
    buffer_load_dwordx4 v[108:111], v46, s[24:27], s43 offen offset:2688
    s_waitcnt vmcnt(0)
    buffer_load_dwordx4 v[112:115], v47, s[24:27], s43 offen offset:0
    buffer_load_dwordx4 v[116:119], v47, s[24:27], s43 offen offset:896
    buffer_load_dwordx4 v[120:123], v47, s[24:27], s43 offen offset:1792
    buffer_load_dwordx4 v[124:127], v47, s[24:27], s43 offen offset:2688
    s_waitcnt vmcnt(0)
    s_mov_b64 exec, -1
    v_perm_b32 v224, v100, v96, s50
    v_perm_b32 v225, v108, v104, s50
    v_perm_b32 v226, v116, v112, s50
    v_perm_b32 v227, v124, v120, s50
    v_perm_b32 v228, v100, v96, s51
    v_perm_b32 v229, v108, v104, s51
    v_perm_b32 v230, v116, v112, s51
    v_perm_b32 v231, v124, v120, s51
    v_perm_b32 v232, v101, v97, s50
    v_perm_b32 v233, v109, v105, s50
    v_perm_b32 v234, v117, v113, s50
    v_perm_b32 v235, v125, v121, s50
    v_perm_b32 v236, v101, v97, s51
    v_perm_b32 v237, v109, v105, s51
    v_perm_b32 v238, v117, v113, s51
    v_perm_b32 v239, v125, v121, s51
    v_perm_b32 v240, v102, v98, s50
    v_perm_b32 v241, v110, v106, s50
    v_perm_b32 v242, v118, v114, s50
    v_perm_b32 v243, v126, v122, s50
    v_perm_b32 v244, v102, v98, s51
    v_perm_b32 v245, v110, v106, s51
    v_perm_b32 v246, v118, v114, s51
    v_perm_b32 v247, v126, v122, s51
    v_perm_b32 v248, v103, v99, s50
    v_perm_b32 v249, v111, v107, s50
    v_perm_b32 v250, v119, v115, s50
    v_perm_b32 v251, v127, v123, s50
    v_perm_b32 v252, v103, v99, s51
    v_perm_b32 v253, v111, v107, s51
    v_perm_b32 v254, v119, v115, s51
    v_perm_b32 v255, v127, v123, s51
    s_and_b32 s42, s3, 1
    s_lshl_b32 s42, s42, 10
    s_lshr_b32 s43, s3, 1
    s_lshl_b32 s46, s43, 2
    s_add_u32 s42, s42, s46
    s_add_u32 s42, s42, 146432
    v_lshl_add_u32 v4, v1, 4, s42
    v_add_u32 v5, 2048, v4
    v_add_u32 v6, 4096, v4
    v_add_u32 v7, 6144, v4
    s_lshl_b32 s46, s43, 3
    s_add_u32 s46, s46, 154624
    v_mov_b32 v8, s46
    s_lshl_b32 s43, s40, 2
    s_add_u32 s42, s43, s3
    s_lshl_b32 s42, s42, 2
    s_add_u32 s42, s42, s23
    s_mul_i32 s42, s42, 1152
    s_add_u32 s42, s42, 1048576
    v_lshl_add_u32 v9, v1, 4, s42
    s_add_u32 s42, s42, 1024
    v_and_b32 v10, 7, v1
    v_lshl_add_u32 v10, v10, 4, s42
    s_add_u32 s42, s43, s23
    s_mul_i32 s42, s42, 4608
    s_add_u32 s42, s42, 1048576
    v_mul_u32_u24 v11, 1152, v3
    v_add_u32 v11, s42, v11
    v_add_u32 v12, 1024, v11
    s_lshl_b32 s46, s3, 8
    v_lshl_add_u32 v11, v2, 4, v11
    v_add_u32 v11, s46, v11
    s_lshl_b32 s42, s3, 6
    s_add_u32 s42, s42, 154688
    v_lshl_add_u32 v13, v2, 2, s42
    v_lshlrev_b32 v14, 4, v3
    v_add_u32 v14, 154688, v14
    s_lshl_b32 s42, s22, 5
    s_lshl_b32 s43, s3, 3
    s_add_u32 s42, s42, s43
    v_lshrrev_b32 v15, 1, v2
    v_add_u32 v15, s42, v15
    v_lshlrev_b32 v15, 5, v15
    v_add_u32 v15, s41, v15
    v_lshlrev_b32 v15, 7, v15
    v_and_b32 v16, 1, v2
    v_lshl_add_u32 v16, v16, 2, v3
    v_lshl_add_u32 v15, v16, 4, v15
    v_add_u32 v15, 2228224, v15
    v_and_b32 v16, 1, v3
    v_cmp_eq_u32 s[54:55], 1, v16
    v_cmp_le_u32 s[48:49], 2, v3
    s_cmp_eq_u32 s3, 1
    s_cbranch_scc0 L_lw2
    v_mov_b32 v16, 155200
    s_mov_b32 s47, 0
L_lwpoll:
    ds_read_b32 v17, v16
    s_add_u32 s47, s47, 1
    s_cmp_gt_u32 s47, 800000
    s_cbranch_scc1 L_lwgo
    s_waitcnt lgkmcnt(0)
    v_readfirstlane_b32 s46, v17
    s_nop 0
    s_cmp_lg_u32 s46, 0
    s_cbranch_scc1 L_lwgo
    s_sleep 8
    s_branch L_lwpoll
L_lwgo:
    s_waitcnt lgkmcnt(0)
    s_lshl_b32 s42, s40, 2
    s_add_u32 s42, s42, s23
    s_mul_i32 s42, s42, 4608
    s_add_u32 s42, s42, 1048576
    v_lshl_add_u32 v16, v1, 4, s42
    global_load_dwordx4 v[96:99], v16, s[18:19] offset:0 sc1
    global_load_dwordx4 v[100:103], v16, s[18:19] offset:1024 sc1
    global_load_dwordx4 v[104:107], v16, s[18:19] offset:2048 sc1
    global_load_dwordx4 v[108:111], v16, s[18:19] offset:3072 sc1
    s_mov_b64 exec, 0xffffffff
    v_add_u32 v16, 4096, v16
    global_load_dwordx4 v[112:115], v16, s[18:19] sc1
    s_mov_b64 exec, -1
    s_waitcnt vmcnt(0)
L_lw2:
    v_mov_b32 v50, s44
    v_mov_b32 v51, s45
    v_mov_b32 v54, s44
    v_mov_b32 v55, s45
    v_mov_b32 v58, s44
    v_mov_b32 v59, s45
    s_barrier
    ds_read_b64 v[16:17], v8 offset:0
    ds_read_b64 v[18:19], v8 offset:16
    ds_read_b64 v[20:21], v8 offset:32
    ds_read_b64 v[22:23], v8 offset:48
    ds_read2_b32 v[24:25], v4 offset0:0 offset1:2
    ds_read2_b32 v[26:27], v5 offset0:0 offset1:2
    ds_read2_b32 v[28:29], v6 offset0:0 offset1:2
    ds_read2_b32 v[30:31], v7 offset0:0 offset1:2
    s_waitcnt lgkmcnt(4)
    v_max3_f32 v52, v16, v18, v20
    v_max_f32 v52, v52, v22
    v_sub_f32 v32, v16, v52
    v_sub_f32 v33, v18, v52
    v_sub_f32 v34, v20, v52
    v_sub_f32 v35, v22, v52
    v_exp_f32 v32, v32
    v_exp_f32 v33, v33
    v_exp_f32 v34, v34
    v_exp_f32 v35, v35
    s_waitcnt lgkmcnt(0)
    v_mul_f32 v48, v32, v24
    v_mul_f32 v49, v32, v25
    v_mul_f32 v53, v32, v17
    v_fmac_f32 v48, v33, v26
    v_fmac_f32 v49, v33, v27
    v_fmac_f32 v53, v33, v19
    v_fmac_f32 v48, v34, v28
    v_fmac_f32 v49, v34, v29
    v_fmac_f32 v53, v34, v21
    v_fmac_f32 v48, v35, v30
    v_fmac_f32 v49, v35, v31
    v_fmac_f32 v53, v35, v23
    s_cmp_eq_u32 s37, 1
    s_cbranch_scc1 L_h1fast
    global_store_dwordx4 v9, v[48:51], s[18:19] sc1
    s_mov_b64 exec, 0xff
    global_store_dwordx4 v10, v[52:55], s[18:19] sc1
    s_mov_b64 exec, -1
    s_sleep 12
    s_branch L_h1pub
L_h1fast:
    global_store_dwordx4 v9, v[48:51], s[18:19]
    s_mov_b64 exec, 0xff
    global_store_dwordx4 v10, v[52:55], s[18:19]
    s_mov_b64 exec, -1
    s_sleep 2
L_h1pub:
    s_mov_b32 s47, 0
L_h1poll:
    global_load_dwordx4 v[16:19], v11, s[18:19] sc1
    global_load_dwordx4 v[20:23], v12, s[18:19] sc1
    s_waitcnt vmcnt(0)
    v_xor_b32 v24, s44, v18
    v_xor_b32 v25, s45, v19
    v_xor_b32 v26, s44, v22
    v_xor_b32 v27, s45, v23
    v_or3_b32 v24, v24, v25, v26
    v_or_b32 v24, v24, v27
    v_cmp_ne_u32 vcc, 0, v24
    s_cbranch_vccz L_h1done
    s_add_u32 s47, s47, 1
    s_cmp_le_u32 s47, 200000
    s_cbranch_scc1 L_h1poll
L_h1done:
    v_mov_b32 v24, v20
    v_mov_b32 v25, v20
    s_nop 1
    v_permlane16_swap_b32 v24, v25
    s_nop 0
    v_max_f32 v24, v24, v25
    v_mov_b32 v25, v24
    s_nop 1
    v_permlane32_swap_b32 v24, v25
    s_nop 0
    v_max_f32 v24, v24, v25
    v_sub_f32 v24, v20, v24
    v_exp_f32 v24, v24
    s_nop 0
    v_mul_f32 v28, v24, v21
    v_mul_f32 v29, v24, v16
    v_mul_f32 v30, v24, v17
    v_mov_b32 v32, v28
    v_mov_b32 v33, v29
    v_mov_b32 v34, v30
    s_nop 0
    v_permlane16_swap_b32 v28, v32
    v_permlane16_swap_b32 v29, v33
    v_permlane16_swap_b32 v30, v34
    s_nop 0
    v_add_f32 v28, v28, v32
    v_add_f32 v29, v29, v33
    v_add_f32 v30, v30, v34
    v_mov_b32 v32, v28
    v_mov_b32 v33, v29
    v_mov_b32 v34, v30
    s_nop 0
    v_permlane32_swap_b32 v28, v32
    v_permlane32_swap_b32 v29, v33
    v_permlane32_swap_b32 v30, v34
    s_nop 0
    v_add_f32 v28, v28, v32
    v_add_f32 v29, v29, v33
    v_add_f32 v30, v30, v34
    v_rcp_f32 v28, v28
    s_nop 0
    v_mul_f32 v29, v29, v28
    v_mul_f32 v30, v30, v28
    v_cvt_pk_bf16_f32 v29, v29, v30
    s_mov_b64 exec, 0xffff
    ds_write_b32 v13, v29
    s_mov_b64 exec, -1
    s_waitcnt lgkmcnt(0)
    s_barrier
    ds_read_b128 v[16:19], v14 offset:0
    ds_read_b128 v[20:23], v14 offset:64
    ds_read_b128 v[24:27], v14 offset:128
    ds_read_b128 v[28:31], v14 offset:192
    s_waitcnt lgkmcnt(3)
    v_mfma_f32_16x16x32_bf16 v[64:67], v[16:19], v[128:131], 0
    v_mfma_f32_16x16x32_bf16 v[68:71], v[16:19], v[132:135], 0
    v_mfma_f32_16x16x32_bf16 v[72:75], v[16:19], v[136:139], 0
    v_mfma_f32_16x16x32_bf16 v[76:79], v[16:19], v[140:143], 0
    v_mfma_f32_16x16x32_bf16 v[80:83], v[16:19], v[144:147], 0
    v_mfma_f32_16x16x32_bf16 v[84:87], v[16:19], v[148:151], 0
    v_mfma_f32_16x16x32_bf16 v[88:91], v[16:19], v[152:155], 0
    v_mfma_f32_16x16x32_bf16 v[92:95], v[16:19], v[156:159], 0
    s_waitcnt lgkmcnt(2)
    v_mfma_f32_16x16x32_bf16 v[64:67], v[20:23], v[160:163], v[64:67]
    v_mfma_f32_16x16x32_bf16 v[68:71], v[20:23], v[164:167], v[68:71]
    v_mfma_f32_16x16x32_bf16 v[72:75], v[20:23], v[168:171], v[72:75]
    v_mfma_f32_16x16x32_bf16 v[76:79], v[20:23], v[172:175], v[76:79]
    v_mfma_f32_16x16x32_bf16 v[80:83], v[20:23], v[176:179], v[80:83]
    v_mfma_f32_16x16x32_bf16 v[84:87], v[20:23], v[180:183], v[84:87]
    v_mfma_f32_16x16x32_bf16 v[88:91], v[20:23], v[184:187], v[88:91]
    v_mfma_f32_16x16x32_bf16 v[92:95], v[20:23], v[188:191], v[92:95]
    s_waitcnt lgkmcnt(1)
    v_mfma_f32_16x16x32_bf16 v[64:67], v[24:27], v[192:195], v[64:67]
    v_mfma_f32_16x16x32_bf16 v[68:71], v[24:27], v[196:199], v[68:71]
    v_mfma_f32_16x16x32_bf16 v[72:75], v[24:27], v[200:203], v[72:75]
    v_mfma_f32_16x16x32_bf16 v[76:79], v[24:27], v[204:207], v[76:79]
    v_mfma_f32_16x16x32_bf16 v[80:83], v[24:27], v[208:211], v[80:83]
    v_mfma_f32_16x16x32_bf16 v[84:87], v[24:27], v[212:215], v[84:87]
    v_mfma_f32_16x16x32_bf16 v[88:91], v[24:27], v[216:219], v[88:91]
    v_mfma_f32_16x16x32_bf16 v[92:95], v[24:27], v[220:223], v[92:95]
    s_waitcnt lgkmcnt(0)
    v_mfma_f32_16x16x32_bf16 v[64:67], v[28:31], v[224:227], v[64:67]
    v_mfma_f32_16x16x32_bf16 v[68:71], v[28:31], v[228:231], v[68:71]
    v_mfma_f32_16x16x32_bf16 v[72:75], v[28:31], v[232:235], v[72:75]
    v_mfma_f32_16x16x32_bf16 v[76:79], v[28:31], v[236:239], v[76:79]
    v_mfma_f32_16x16x32_bf16 v[80:83], v[28:31], v[240:243], v[80:83]
    v_mfma_f32_16x16x32_bf16 v[84:87], v[28:31], v[244:247], v[84:87]
    v_mfma_f32_16x16x32_bf16 v[88:91], v[28:31], v[248:251], v[88:91]
    v_mfma_f32_16x16x32_bf16 v[92:95], v[28:31], v[252:255], v[92:95]
    s_nop 4
    v_cndmask_b32 v60, v64, v72, s[54:55]
    v_cndmask_b32 v61, v68, v76, s[54:55]
    s_nop 0
    v_cndmask_b32 v62, v80, v88, s[54:55]
    s_nop 1
    v_cndmask_b32 v63, v84, v92, s[54:55]
    v_cndmask_b32 v56, v60, v62, s[48:49]
    v_cndmask_b32 v57, v61, v63, s[48:49]
    s_mov_b64 exec, s[52:53]
    global_store_dwordx4 v15, v[56:59], s[18:19] sc1
    s_mov_b64 exec, -1
    s_cmp_eq_u32 s3, 0
    s_cbranch_scc0 L_end
    s_cmp_lt_u32 s41, 28
    s_cbranch_scc0 L_end
    s_lshl_b32 s42, s22, 5
    s_add_u32 s42, s42, s41
    s_lshl_b32 s42, s42, 12
    s_add_u32 s42, s42, 2228224
    v_lshl_add_u32 v6, v1, 4, s42
    s_sleep 12
    s_mov_b32 s47, 0
L_h2poll:
    global_load_dwordx4 v[16:19], v6, s[18:19] offset:0 sc1
    global_load_dwordx4 v[20:23], v6, s[18:19] offset:1024 sc1
    global_load_dwordx4 v[24:27], v6, s[18:19] offset:2048 sc1
    global_load_dwordx4 v[28:31], v6, s[18:19] offset:3072 sc1
    s_waitcnt vmcnt(0)
    v_xor_b32 v32, s44, v18
    v_xor_b32 v33, s45, v19
    v_or_b32 v32, v32, v33
    v_xor_b32 v33, s44, v22
    v_xor_b32 v34, s45, v23
    v_or3_b32 v32, v32, v33, v34
    v_xor_b32 v33, s44, v26
    v_xor_b32 v34, s45, v27
    v_or3_b32 v32, v32, v33, v34
    v_xor_b32 v33, s44, v30
    v_xor_b32 v34, s45, v31
    v_or3_b32 v32, v32, v33, v34
    v_cmp_ne_u32 vcc, 0, v32
    s_cbranch_vccz L_h2done
    s_add_u32 s47, s47, 1
    s_cmp_le_u32 s47, 200000
    s_cbranch_scc1 L_h2poll
L_h2done:
    v_add_f32 v16, v16, v20
    v_add_f32 v24, v24, v28
    v_add_f32 v17, v17, v21
    v_add_f32 v25, v25, v29
    v_add_f32 v16, v16, v24
    v_add_f32 v17, v17, v25
    s_nop 1
    v_add_f32_dpp v20, v16, v16 row_ror:8 row_mask:0xf bank_mask:0xf
    v_add_f32_dpp v21, v17, v17 row_ror:8 row_mask:0xf bank_mask:0xf
    v_mov_b32 v16, v20
    v_mov_b32 v17, v21
    s_nop 1
    v_permlane16_swap_b32 v16, v20
    v_permlane16_swap_b32 v17, v21
    s_nop 1
    v_add_f32 v16, v16, v20
    v_add_f32 v17, v17, v21
    v_mov_b32 v20, v16
    v_mov_b32 v21, v17
    s_nop 1
    v_permlane32_swap_b32 v16, v20
    v_permlane32_swap_b32 v17, v21
    s_nop 1
    v_add_f32 v16, v16, v20
    v_add_f32 v17, v17, v21
    v_cvt_pk_bf16_f32 v24, v16, v17
    s_mul_i32 s42, s22, 896
    s_lshl_b32 s43, s41, 5
    s_add_u32 s42, s42, s43
    v_lshl_add_u32 v6, v1, 2, s42
    s_mov_b64 exec, 0xff
    global_store_dword v6, v24, s[14:15]
    s_or_b32 s46, s41, s22
    s_cmp_lg_u32 s46, 0
    s_cbranch_scc1 L_end
    s_mov_b32 s46, 3276800
    s_mov_b64 exec, 1
    v_mov_b32 v10, s46
    v_mov_b32 v12, s44
    v_mov_b32 v13, s45
    global_store_dwordx2 v10, v[12:13], s[18:19] sc1
    s_branch L_end
L_end:
    s_endpgm
.section .rodata,"a"
.p2align 6
.amdhsa_kernel standalone__gqa_block_cached__decode_kernel
  .amdhsa_next_free_vgpr 256
  .amdhsa_next_free_sgpr 96
  .amdhsa_accum_offset 256
  .amdhsa_group_segment_fixed_size 0
  .amdhsa_kernarg_size 64
  .amdhsa_user_sgpr_count 2
  .amdhsa_user_sgpr_kernarg_segment_ptr 1
  .amdhsa_system_sgpr_workgroup_id_x 1
.end_amdhsa_kernel
```
